```python
import torch

def _softmax(x, axis=-1):
    return torch.softmax(x, dim=axis)
def _gelu(x):
    return torch.nn.functional.gelu(x, approximate="tanh")
def _silu(x):
    return torch.nn.functional.silu(x)
def _sigmoid(x):
    return torch.sigmoid(x)
def _layernorm(x, axis=-1, eps=1e-5):
    m = x.mean(dim=axis, keepdim=True)
    v = x.var(dim=axis, keepdim=True, unbiased=False)
    return (x - m) / torch.sqrt(v + eps)
def _scatter_add(tgt, idx, src, axis=0):
    return tgt.clone().index_add_(axis, idx, src)
def _segment_sum(src, seg, n):
    out = torch.zeros((n,) + src.shape[1:], dtype=src.dtype)
    return out.index_add_(0, seg, src)
def _pad(x, pw):
    flat = tuple(v for pair in reversed(pw) for v in pair)
    return torch.nn.functional.pad(x, flat)

kernel_name = 'parallel_sum__ssm_conv_s5__dense_activation_relu__prompt'

def setup_inputs():

    _w = (lambda a: (lambda t: t.to(torch.bfloat16) if t.is_floating_point() else t)(torch.as_tensor(a)))
    def _A_setup():
        B, S, D = 1, 2048, 512
        P = D
        Lambda_re = -0.5 * (lambda _x: torch.exp(torch.as_tensor(_x)))((lambda *s: torch.randn(*s, dtype=torch.bfloat16) * 0.8)(P))
        Lambda_im = (lambda *s: torch.randn(*s, dtype=torch.bfloat16) * 0.8)(P) * 1.0
        B_re = (lambda *s: torch.randn(*s, dtype=torch.bfloat16) * 0.8)(P, D) * (D ** -0.5)
        B_im = (lambda *s: torch.randn(*s, dtype=torch.bfloat16) * 0.8)(P, D) * (D ** -0.5)
        C_re = (lambda *s: torch.randn(*s, dtype=torch.bfloat16) * 0.8)(D, P) * (P ** -0.5)
        C_im = (lambda *s: torch.randn(*s, dtype=torch.bfloat16) * 0.8)(D, P) * (P ** -0.5)
        log_dt = (lambda *s: torch.randn(*s, dtype=torch.bfloat16) * 0.8)(P) * 0.3 - 2.0
        Dskip = (lambda *s: torch.randn(*s, dtype=torch.bfloat16) * 0.8)(D)
        return {
            "x": _w((lambda *s: torch.randn(*s, dtype=torch.bfloat16) * 0.05)(B, S, D)),
            "Lambda_re": _w(Lambda_re),
            "Lambda_im": _w(Lambda_im),
            "B_re": _w(B_re),
            "B_im": _w(B_im),
            "C_re": _w(C_re),
            "C_im": _w(C_im),
            "log_dt": _w(log_dt),
            "Dskip": _w(Dskip),
        }
    _A_in = _A_setup()

    def _B_setup():
        B, S, D, Dff = 1, 2048, 512, 1376
        return {
            "x": _w((lambda *s: torch.randn(*s, dtype=torch.bfloat16) * 0.05)(B, S, D)),
            "w1": _w((lambda *s: torch.randn(*s, dtype=torch.bfloat16) * 0.05)(D, Dff)),
            "w2": _w((lambda *s: torch.randn(*s, dtype=torch.bfloat16) * 0.05)(Dff, D)),
        }
    _B_in = _B_setup()

    return {
        "A_x": _A_in["x"],
        "A_Lambda_re": _A_in["Lambda_re"],
        "A_Lambda_im": _A_in["Lambda_im"],
        "A_B_re": _A_in["B_re"],
        "A_B_im": _A_in["B_im"],
        "A_C_re": _A_in["C_re"],
        "A_C_im": _A_in["C_im"],
        "A_log_dt": _A_in["log_dt"],
        "A_Dskip": _A_in["Dskip"],
        "B_x": _B_in["x"],
        "B_w1": _B_in["w1"],
        "B_w2": _B_in["w2"],
    }

def reference(A_x, A_Lambda_re, A_Lambda_im, A_B_re, A_B_im, A_C_re, A_C_im, A_log_dt, A_Dskip, B_x, B_w1, B_w2):
    def _A_ref(x, Lambda_re, Lambda_im, B_re, B_im, C_re, C_im, log_dt, Dskip):
        Bsz, L, H = x.shape
        Lam = Lambda_re + 1j * Lambda_im
        Bmat = B_re + 1j * B_im
        Cmat = C_re + 1j * C_im
        dt = torch.exp(log_dt)
        Lam_bar = torch.exp(dt * Lam)
        B_bar = ((Lam_bar - 1.0) / Lam)[:, None] * Bmat
        Bu = torch.einsum("bld,pd->blp", x + 0j, B_bar)
        h = torch.zeros_like(Bu[:, 0, :])
        hs = []
        for t in range(L):
            h = Lam_bar[None, :] * h + Bu[:, t, :]
            hs.append(h)
        hseq = torch.stack(hs, 1)
        y = 2.0 * torch.einsum("blp,dp->bld", hseq, Cmat).real + x * Dskip[None, None, :]
        return y

    def _B_ref(x, w1, w2):
        h = torch.einsum("bsd,df->bsf", x, w1)
        zero = torch.zeros_like(h)
        h = torch.maximum(h, zero)
        return torch.einsum("bsf,fd->bsd", h, w2)

    x = A_x
    xn = _layernorm(x, axis=-1)
    return x + _A_ref(xn, A_Lambda_re, A_Lambda_im, A_B_re, A_B_im, A_C_re, A_C_im, A_log_dt, A_Dskip) + _B_ref(xn, B_w1, B_w2)
```

```asm
; @launch grid=(256,1,1) block=(512,1,1) lds=163840
.amdgcn_target "amdgcn-amd-amdhsa--gfx950"
.text
.globl parallel_sum__ssm_conv_s5__dense_activation_relu__prompt_kernel
.p2align 8
.type parallel_sum__ssm_conv_s5__dense_activation_relu__prompt_kernel,@function
parallel_sum__ssm_conv_s5__dense_activation_relu__prompt_kernel:
    s_cmp_ge_u32 s2, 256
    s_cbranch_scc1 END
    s_load_dwordx2 s[48:49], s[0:1], 0
    s_load_dwordx4 s[44:47], s[0:1], 24
    s_getpc_b64 s[12:13]
PF0:
    s_lshr_b32 s14, s2, 3
    s_mul_i32 s14, s14, 768
    s_min_u32 s14, s14, END-PF0-640
    s_add_u32 s12, s12, s14
    s_addc_u32 s13, s13, 0
    v_min_u32 v2, 5, v0
    v_lshlrev_b32 v2, 7, v2
    v_mov_b32 v3, s13
    v_add_co_u32 v2, vcc, s12, v2
    s_nop 1
    v_addc_co_u32 v3, vcc, 0, v3, vcc
    global_load_dword v127, v[2:3], off
    v_lshrrev_b32 v1, 6, v0
    v_and_b32 v0, 63, v0
    v_readfirstlane_b32 s9, v1
    s_and_b32 s13, s2, 7
    s_lshr_b32 s14, s2, 3
    s_lshr_b32 s4, s14, 2
    s_lshl_b32 s4, s4, 1
    s_and_b32 s15, s13, 1
    s_add_u32 s4, s4, s15
    s_lshr_b32 s5, s13, 1
    s_lshl_b32 s5, s5, 2
    s_and_b32 s15, s14, 3
    s_add_u32 s5, s5, s15
    s_and_b32 s3, s9, 3
    s_mov_b32 s50, 2097152
    s_mov_b32 s51, 0x20000
    s_lshr_b32 s8, s4, 1
    s_lshr_b32 s13, s5, 2
    s_lshl_b32 s13, s13, 1
    s_add_u32 s8, s8, s13
    s_and_b32 s8, s8, 7
    s_lshl_b32 s16, s4, 17
    s_lshl_b32 s13, s9, 13
    s_add_u32 s16, s16, s13
    s_lshl_b32 s20, s9, 10
    v_lshrrev_b32 v2, 4, v0
    s_and_b32 s13, s3, 1
    s_lshl_b32 s13, s13, 2
    v_add_u32 v2, s13, v2
    v_xor_b32 v2, v2, v0
    v_and_b32 v2, 7, v2
    v_lshlrev_b32 v2, 4, v2
    v_lshrrev_b32 v3, 3, v0
    v_lshl_or_b32 v1, v3, 10, v2
    s_waitcnt lgkmcnt(0)
    s_lshl_b32 s12, s8, 7
    s_add_u32 m0, s20, 0
    s_add_u32 s13, s16, s12
    buffer_load_dwordx4 v1, s[48:51], s13 offen lds
    s_add_u32 m0, s20, 8192
    s_add_u32 s13, s13, 65536
    buffer_load_dwordx4 v1, s[48:51], s13 offen lds
    s_mov_b32 s54, 524288
    s_mov_b32 s55, 0x20000
    s_lshl_b32 s19, s5, 15
    s_lshl_b32 s13, s3, 13
    s_add_u32 s19, s19, s13
    s_add_u32 s21, s20, 65536
    s_cmp_ge_u32 s9, 4
    s_cselect_b64 s[52:53], s[46:47], s[44:45]
    s_add_u32 m0, s21, 0
    s_add_u32 s13, s19, s12
    s_add_u32 s8, s8, 1
    s_and_b32 s8, s8, 7
    buffer_load_dwordx4 v1, s[52:55], s13 offen lds
    s_load_dwordx2 s[68:69], s[0:1], 104
    s_memrealtime s[78:79]
    s_mov_b32 s70, 256
    s_mov_b32 s71, 0x20000
    s_load_dwordx2 s[56:57], s[0:1], 88
    s_load_dwordx2 s[60:61], s[0:1], 112
    s_mov_b32 s58, 1409024
    s_mov_b32 s59, 0x20000
    s_mov_b32 s62, 33554432
    s_mov_b32 s63, 0x20000
    s_lshr_b32 s7, s5, 3
    s_and_b32 s6, s5, 7
    s_mov_b32 s25, 0xffff0000
    v_lshrrev_b32 v2, 2, v0
    v_and_b32 v2, 4, v2
    v_xor_b32 v2, v2, v0
    v_and_b32 v2, 7, v2
    v_lshlrev_b32 v2, 4, v2
    v_lshl_or_b32 v5, v3, 10, v2
    v_and_b32 v2, 3, v0
    v_bfe_u32 v3, v0, 2, 1
    v_lshl_or_b32 v2, v3, 4, v2
    v_bfe_u32 v3, v0, 3, 2
    v_lshl_or_b32 v2, v3, 2, v2
    v_lshrrev_b32 v3, 1, v2
    v_and_b32 v3, 7, v3
    v_lshrrev_b32 v4, 5, v0
    v_xor_b32 v3, v3, v4
    s_lshl_b32 s13, s3, 1
    v_xor_b32 v3, s13, v3
    v_lshlrev_b32 v3, 4, v3
    s_lshl_b32 s13, s3, 12
    v_lshl_add_u32 v2, v2, 7, s13
    v_add_u32 v8, v2, v3
    v_xor_b32 v9, 32, v8
    v_xor_b32 v10, 64, v8
    v_xor_b32 v11, 96, v8
    s_lshl_b32 s12, s8, 7
    s_add_u32 m0, s20, 16384
    s_add_u32 s13, s16, s12
    buffer_load_dwordx4 v1, s[48:51], s13 offen lds
    s_add_u32 m0, s20, 24576
    s_add_u32 s13, s13, 65536
    buffer_load_dwordx4 v1, s[48:51], s13 offen lds
    s_add_u32 m0, s21, 8192
    s_add_u32 s13, s19, s12
    s_add_u32 s8, s8, 1
    s_and_b32 s8, s8, 7
    buffer_load_dwordx4 v1, s[52:55], s13 offen lds
    s_lshl_b32 s13, s2, 3
    s_add_u32 s13, s13, s9
    v_mov_b32 v4, 0
    s_waitcnt lgkmcnt(0)
    s_cmp_eq_u32 s13, 7
    s_cbranch_scc0 NONON
    s_or_b32 s12, s78, 1
    v_mov_b32 v6, s12
    s_mov_b64 exec, 1
    buffer_store_dword v6, v4, s[68:71], 0 offen sc1
    s_mov_b64 exec, -1
NONON:
    s_mul_i32 s26, s3, 12288
    s_add_u32 s27, s26, 98304
    s_lshl_b32 s28, s3, 13
    s_add_u32 s28, s28, 65536
    s_lshl_b32 s13, s4, 2
    s_add_u32 s14, s13, s3
    s_mul_i32 s30, s14, 153600
    s_lshl_b32 s14, s7, 1
    s_add_u32 s14, s14, s13
    s_mul_i32 s31, s14, 153600
    s_lshl_b32 s32, s4, 1
    s_add_u32 s32, s32, s7
    s_lshl_b32 s32, s32, 12
    s_add_u32 s32, s32, 17825792
    s_cmp_ge_u32 s9, 4
    s_cbranch_scc1 S_START
    s_load_dwordx2 s[64:65], s[0:1], 80
    s_load_dwordx2 s[68:69], s[0:1], 96
    s_load_dwordx2 s[76:77], s[0:1], 64
    s_mov_b64 s[72:73], s[46:47]
    s_mov_b32 s74, 524288
    s_mov_b32 s75, 0x20000
    s_setprio 1
    s_mov_b32 s66, 1409024
    s_mov_b32 s67, 0x20000
    s_mov_b32 s70, 4194304
    s_mov_b32 s71, 0x20000
    s_mov_b32 s78, 1024
    s_mov_b32 s79, 0x20000
    s_mul_i32 s12, s5, 6
    s_lshl_b32 s13, s5, 2
    s_add_u32 s13, s13, 22
    s_min_u32 s10, s12, s13
    s_lshl_b32 s18, s10, 5
    s_mul_i32 s12, s3, 44032
    s_add_u32 s18, s18, s12
    s_mul_i32 s23, s3, 3072
    s_sub_u32 s101, s8, 2
    s_and_b32 s101, s101, 7
    s_mul_i32 s33, s3, 311296
    s_lshl_b32 s12, s6, 7
    s_add_u32 s33, s33, s12
    s_lshr_b32 s12, s4, 1
    s_mul_i32 s12, s12, 2
    s_mul_i32 s13, s6, 0
    s_add_u32 s12, s12, s13
    s_sub_u32 s13, s12, 19
    s_cmp_ge_u32 s12, 19
    s_cselect_b32 s12, s13, s12
    s_sub_u32 s13, s12, 19
    s_cmp_ge_u32 s12, 19
    s_cselect_b32 s12, s13, s12
    s_sub_u32 s13, s12, 19
    s_cmp_ge_u32 s12, 19
    s_cselect_b32 s12, s13, s12
    s_lshl_b32 s17, s12, 10
    s_lshl_b32 s12, s12, 14
    s_add_u32 s39, s33, s12
    s_add_u32 s100, s33, 311296
    v_add_u32 v6, 0, v0
    v_mul_u32_u24 v12, 43691, v6
    v_lshrrev_b32 v12, 19, v12
    v_mul_u32_u24 v13, 12, v12
    v_sub_u32 v6, v6, v13
    v_lshlrev_b32 v6, 4, v6
    v_mul_u32_u24 v12, 2752, v12
    v_add_u32 v2, v6, v12
    v_add_u32 v6, 64, v0
    v_mul_u32_u24 v12, 43691, v6
    v_lshrrev_b32 v12, 19, v12
    v_mul_u32_u24 v13, 12, v12
    v_sub_u32 v6, v6, v13
    v_lshlrev_b32 v6, 4, v6
    v_mul_u32_u24 v12, 2752, v12
    v_add_u32 v6, v6, v12
    v_subrev_u32 v3, 1024, v6
    v_add_u32 v6, 128, v0
    v_mul_u32_u24 v12, 43691, v6
    v_lshrrev_b32 v12, 19, v12
    v_mul_u32_u24 v13, 12, v12
    v_sub_u32 v6, v6, v13
    v_lshlrev_b32 v6, 4, v6
    v_mul_u32_u24 v12, 2752, v12
    v_add_u32 v6, v6, v12
    v_subrev_u32 v4, 2048, v6
    v_bfe_u32 v6, v0, 2, 2
    v_lshrrev_b32 v16, 5, v0
    v_lshl_add_u32 v6, v16, 3, v6
    v_mul_u32_u24 v6, 192, v6
    v_bfe_u32 v16, v0, 4, 1
    v_lshl_add_u32 v6, v16, 5, v6
    v_and_b32 v16, 3, v0
    v_lshl_add_u32 v6, v16, 3, v6
    s_xor_b32 s12, s3, 0
    s_mul_i32 s12, s12, 3072
    s_add_u32 s12, s12, 98304
    v_add_u32 v12, s12, v6
    s_xor_b32 s12, s3, 1
    s_mul_i32 s12, s12, 3072
    s_add_u32 s12, s12, 98304
    v_add_u32 v13, s12, v6
    s_xor_b32 s12, s3, 2
    s_mul_i32 s12, s12, 3072
    s_add_u32 s12, s12, 98304
    v_add_u32 v14, s12, v6
    s_xor_b32 s12, s3, 3
    s_mul_i32 s12, s12, 3072
    s_add_u32 s12, s12, 98304
    v_add_u32 v15, s12, v6
    v_bfe_u32 v112, v0, 4, 1
    v_lshlrev_b32 v112, 2, v112
    v_and_b32 v113, 15, v0
    v_mov_b32 v114, 0x3f803f80
    v_add_u32 v115, 8, v112
    v_cmp_eq_u32 vcc, v115, v113
    s_nop 1
    v_cndmask_b32 v116, 0, v114, vcc
    v_cmp_eq_u32 vcc, v112, v113
    s_nop 1
    v_cndmask_b32 v112, 0, v114, vcc
    v_mov_b32 v113, v112
    v_mov_b32 v117, v116
    v_mov_b32 v114, v112
    v_mov_b32 v118, v116
    v_mov_b32 v115, v112
    v_mov_b32 v119, v116
    v_or_b32 v120, v112, v116
    v_or_b32 v121, v112, v116
    v_or_b32 v122, v112, v116
    v_or_b32 v123, v112, v116
    v_and_b32 v62, 3, v0
    v_bfe_u32 v16, v0, 2, 1
    v_lshl_or_b32 v62, v16, 4, v62
    v_bfe_u32 v16, v0, 3, 2
    v_lshl_or_b32 v62, v16, 2, v62
    s_lshl_b32 s12, s3, 5
    v_add_u32 v62, s12, v62
    v_lshlrev_b32 v62, 2, v62
    v_add_u32 v62, 147456, v62
    v_bfe_u32 v63, v0, 2, 2
    v_lshrrev_b32 v16, 5, v0
    v_lshl_add_u32 v63, v16, 2, v63
    v_lshlrev_b32 v63, 7, v63
    v_bfe_u32 v16, v0, 3, 1
    v_lshl_add_u32 v63, v16, 6, v63
    v_bfe_u32 v16, v0, 4, 1
    v_lshl_add_u32 v63, v16, 5, v63
    v_and_b32 v16, 3, v0
    v_lshl_add_u32 v63, v16, 3, v63
    s_and_b32 s12, s3, 1
    s_lshl_b32 s12, s12, 6
    v_xor_b32 v63, s12, v63
    v_and_b32 v55, 31, v0
    v_lshlrev_b32 v55, 4, v55
    v_add_u32 v55, 150528, v55
    v_mov_b32 v7, 148992
    v_mov_b32 v53, 1
    v_cmp_gt_u32 s[34:35], 32, v0
    s_lshl_b32 s12, s3, 8
    s_add_u32 s12, s12, 149504
    v_lshl_add_u32 v60, v0, 2, s12
    v_lshlrev_b32 v0, 4, v0
    s_lshl_b32 s12, s3, 2
    s_add_u32 s12, s12, 150528
    v_add_u32 v54, s12, v0
    s_mov_b32 s44, 0xaaaaaaaa
    s_mov_b32 s45, s44
    s_mov_b32 s46, 0xcccccccc
    s_mov_b32 s47, s46
    s_waitcnt lgkmcnt(0)
    s_lshl_b32 s12, s8, 7
    s_add_u32 m0, s20, 32768
    s_add_u32 s13, s16, s12
    buffer_load_dwordx4 v1, s[48:51], s13 offen lds
    s_add_u32 m0, s20, 36864
    s_add_u32 s13, s13, 32768
    buffer_load_dwordx4 v1, s[48:51], s13 offen lds
    s_add_u32 m0, s20, 40960
    s_add_u32 s13, s13, 32768
    buffer_load_dwordx4 v1, s[48:51], s13 offen lds
    s_add_u32 m0, s20, 45056
    s_add_u32 s13, s13, 32768
    buffer_load_dwordx4 v1, s[48:51], s13 offen lds
    s_add_u32 m0, s21, 16384
    s_add_u32 s13, s19, s12
    buffer_load_dwordx4 v1, s[52:55], s13 offen lds
    s_add_u32 m0, s21, 20480
    s_add_u32 s8, s8, 1
    s_and_b32 s8, s8, 7
    buffer_load_dwordx4 v1, s[72:75], s13 offen lds
    s_waitcnt vmcnt(9)
    s_barrier
    ds_read_b128 a[0:3], v8 offset:0
    ds_read_b128 a[4:7], v9 offset:0
    ds_read_b128 a[8:11], v10 offset:0
    ds_read_b128 a[12:15], v11 offset:0
    s_lshl_b32 s12, s8, 7
    s_add_u32 m0, s20, 49152
    s_add_u32 s13, s16, s12
    buffer_load_dwordx4 v1, s[48:51], s13 offen lds
    s_add_u32 m0, s20, 53248
    s_add_u32 s13, s13, 32768
    buffer_load_dwordx4 v1, s[48:51], s13 offen lds
    s_add_u32 m0, s20, 57344
    s_add_u32 s13, s13, 32768
    buffer_load_dwordx4 v1, s[48:51], s13 offen lds
    s_add_u32 m0, s20, 61440
    s_add_u32 s13, s13, 32768
    buffer_load_dwordx4 v1, s[48:51], s13 offen lds
    s_add_u32 m0, s21, 24576
    s_add_u32 s13, s19, s12
    buffer_load_dwordx4 v1, s[52:55], s13 offen lds
    s_add_u32 m0, s21, 28672
    s_add_u32 s8, s8, 1
    s_and_b32 s8, s8, 7
    buffer_load_dwordx4 v1, s[72:75], s13 offen lds
    s_waitcnt vmcnt(12) lgkmcnt(0)
    s_barrier
    ds_read_b128 a[16:19], v8 offset:16384
    ds_read_b128 a[20:23], v9 offset:16384
    ds_read_b128 a[24:27], v10 offset:16384
    ds_read_b128 a[28:31], v11 offset:16384
    s_lshl_b32 s12, s8, 7
    s_add_u32 m0, s20, 0
    s_add_u32 s13, s16, s12
    buffer_load_dwordx4 v1, s[48:51], s13 offen lds
    v_mfma_f32_4x4x4_16b_bf16 v[16:19], a[0:1], a[0:1], 0
    v_mfma_f32_4x4x4_16b_bf16 v[20:23], a[2:3], a[2:3], 0
    s_add_u32 m0, s20, 4096
    s_add_u32 s13, s13, 32768
    buffer_load_dwordx4 v1, s[48:51], s13 offen lds
    v_mfma_f32_16x16x32_bf16 v[124:127], v[120:123], a[0:3], 0
    v_mfma_f32_4x4x4_16b_bf16 v[16:19], a[4:5], a[4:5], v[16:19]
    s_add_u32 m0, s20, 8192
    s_add_u32 s13, s13, 32768
    buffer_load_dwordx4 v1, s[48:51], s13 offen lds
    v_mfma_f32_4x4x4_16b_bf16 v[20:23], a[6:7], a[6:7], v[20:23]
    v_mfma_f32_16x16x32_bf16 v[124:127], v[120:123], a[4:7], v[124:127]
    s_add_u32 m0, s20, 12288
    s_add_u32 s13, s13, 32768
    buffer_load_dwordx4 v1, s[48:51], s13 offen lds
    v_mfma_f32_4x4x4_16b_bf16 v[16:19], a[8:9], a[8:9], v[16:19]
    v_mfma_f32_4x4x4_16b_bf16 v[20:23], a[10:11], a[10:11], v[20:23]
    s_add_u32 m0, s21, 0
    s_add_u32 s13, s19, s12
    buffer_load_dwordx4 v1, s[52:55], s13 offen lds
    v_mfma_f32_16x16x32_bf16 v[124:127], v[120:123], a[8:11], v[124:127]
    v_mfma_f32_4x4x4_16b_bf16 v[16:19], a[12:13], a[12:13], v[16:19]
    s_add_u32 m0, s21, 4096
    s_add_u32 s8, s8, 1
    s_and_b32 s8, s8, 7
    buffer_load_dwordx4 v1, s[72:75], s13 offen lds
    v_mfma_f32_4x4x4_16b_bf16 v[20:23], a[14:15], a[14:15], v[20:23]
    v_mfma_f32_16x16x32_bf16 v[124:127], v[120:123], a[12:15], v[124:127]
    s_waitcnt vmcnt(12) lgkmcnt(0)
    s_barrier
    ds_read_b128 a[32:35], v8 offset:32768
    ds_read_b128 a[36:39], v9 offset:32768
    ds_read_b128 a[40:43], v10 offset:32768
    ds_read_b128 a[44:47], v11 offset:32768
    s_lshl_b32 s12, s8, 7
    s_add_u32 m0, s20, 16384
    s_add_u32 s13, s16, s12
    buffer_load_dwordx4 v1, s[48:51], s13 offen lds
    v_mfma_f32_4x4x4_16b_bf16 v[16:19], a[16:17], a[16:17], v[16:19]
    v_mfma_f32_4x4x4_16b_bf16 v[20:23], a[18:19], a[18:19], v[20:23]
    s_add_u32 m0, s20, 20480
    s_add_u32 s13, s13, 32768
    buffer_load_dwordx4 v1, s[48:51], s13 offen lds
    v_mfma_f32_16x16x32_bf16 v[124:127], v[120:123], a[16:19], v[124:127]
    v_mfma_f32_4x4x4_16b_bf16 v[16:19], a[20:21], a[20:21], v[16:19]
    s_add_u32 m0, s20, 24576
    s_add_u32 s13, s13, 32768
    buffer_load_dwordx4 v1, s[48:51], s13 offen lds
    v_mfma_f32_4x4x4_16b_bf16 v[20:23], a[22:23], a[22:23], v[20:23]
    v_mfma_f32_16x16x32_bf16 v[124:127], v[120:123], a[20:23], v[124:127]
    s_add_u32 m0, s20, 28672
    s_add_u32 s13, s13, 32768
    buffer_load_dwordx4 v1, s[48:51], s13 offen lds
    v_mfma_f32_4x4x4_16b_bf16 v[16:19], a[24:25], a[24:25], v[16:19]
    v_mfma_f32_4x4x4_16b_bf16 v[20:23], a[26:27], a[26:27], v[20:23]
    s_add_u32 m0, s21, 8192
    s_add_u32 s13, s19, s12
    buffer_load_dwordx4 v1, s[52:55], s13 offen lds
    v_mfma_f32_16x16x32_bf16 v[124:127], v[120:123], a[24:27], v[124:127]
    v_mfma_f32_4x4x4_16b_bf16 v[16:19], a[28:29], a[28:29], v[16:19]
    s_add_u32 m0, s21, 12288
    s_add_u32 s8, s8, 1
    s_and_b32 s8, s8, 7
    buffer_load_dwordx4 v1, s[72:75], s13 offen lds
    v_mfma_f32_4x4x4_16b_bf16 v[20:23], a[30:31], a[30:31], v[20:23]
    v_mfma_f32_16x16x32_bf16 v[124:127], v[120:123], a[28:31], v[124:127]
    s_waitcnt vmcnt(12) lgkmcnt(0)
    s_barrier
    ds_read_b128 a[48:51], v8 offset:49152
    ds_read_b128 a[52:55], v9 offset:49152
    ds_read_b128 a[56:59], v10 offset:49152
    ds_read_b128 a[60:63], v11 offset:49152
    s_lshl_b32 s12, s8, 7
    s_add_u32 m0, s20, 32768
    s_add_u32 s13, s16, s12
    buffer_load_dwordx4 v1, s[48:51], s13 offen lds
    v_mfma_f32_4x4x4_16b_bf16 v[16:19], a[32:33], a[32:33], v[16:19]
    v_mfma_f32_4x4x4_16b_bf16 v[20:23], a[34:35], a[34:35], v[20:23]
    s_add_u32 m0, s20, 36864
    s_add_u32 s13, s13, 32768
    buffer_load_dwordx4 v1, s[48:51], s13 offen lds
    v_mfma_f32_16x16x32_bf16 v[124:127], v[120:123], a[32:35], v[124:127]
    v_mfma_f32_4x4x4_16b_bf16 v[16:19], a[36:37], a[36:37], v[16:19]
    s_add_u32 m0, s20, 40960
    s_add_u32 s13, s13, 32768
    buffer_load_dwordx4 v1, s[48:51], s13 offen lds
    v_mfma_f32_4x4x4_16b_bf16 v[20:23], a[38:39], a[38:39], v[20:23]
    v_mfma_f32_16x16x32_bf16 v[124:127], v[120:123], a[36:39], v[124:127]
    s_add_u32 m0, s20, 45056
    s_add_u32 s13, s13, 32768
    buffer_load_dwordx4 v1, s[48:51], s13 offen lds
    v_mfma_f32_4x4x4_16b_bf16 v[16:19], a[40:41], a[40:41], v[16:19]
    v_mfma_f32_4x4x4_16b_bf16 v[20:23], a[42:43], a[42:43], v[20:23]
    s_add_u32 m0, s21, 16384
    s_add_u32 s13, s19, s12
    buffer_load_dwordx4 v1, s[52:55], s13 offen lds
    v_mfma_f32_16x16x32_bf16 v[124:127], v[120:123], a[40:43], v[124:127]
    v_mfma_f32_4x4x4_16b_bf16 v[16:19], a[44:45], a[44:45], v[16:19]
    s_add_u32 m0, s21, 20480
    s_add_u32 s8, s8, 1
    s_and_b32 s8, s8, 7
    buffer_load_dwordx4 v1, s[72:75], s13 offen lds
    v_mfma_f32_4x4x4_16b_bf16 v[20:23], a[46:47], a[46:47], v[20:23]
    v_mfma_f32_16x16x32_bf16 v[124:127], v[120:123], a[44:47], v[124:127]
    s_waitcnt vmcnt(12) lgkmcnt(0)
    s_barrier
    ds_read_b128 a[64:67], v8 offset:0
    ds_read_b128 a[68:71], v9 offset:0
    ds_read_b128 a[72:75], v10 offset:0
    ds_read_b128 a[76:79], v11 offset:0
    s_lshl_b32 s12, s8, 7
    s_add_u32 m0, s20, 49152
    s_add_u32 s13, s16, s12
    buffer_load_dwordx4 v1, s[48:51], s13 offen lds
    v_mfma_f32_4x4x4_16b_bf16 v[16:19], a[48:49], a[48:49], v[16:19]
    v_mfma_f32_4x4x4_16b_bf16 v[20:23], a[50:51], a[50:51], v[20:23]
    s_add_u32 m0, s20, 53248
    s_add_u32 s13, s13, 32768
    buffer_load_dwordx4 v1, s[48:51], s13 offen lds
    v_mfma_f32_16x16x32_bf16 v[124:127], v[120:123], a[48:51], v[124:127]
    v_mfma_f32_4x4x4_16b_bf16 v[16:19], a[52:53], a[52:53], v[16:19]
    s_add_u32 m0, s20, 57344
    s_add_u32 s13, s13, 32768
    buffer_load_dwordx4 v1, s[48:51], s13 offen lds
    v_mfma_f32_4x4x4_16b_bf16 v[20:23], a[54:55], a[54:55], v[20:23]
    v_mfma_f32_16x16x32_bf16 v[124:127], v[120:123], a[52:55], v[124:127]
    s_add_u32 m0, s20, 61440
    s_add_u32 s13, s13, 32768
    buffer_load_dwordx4 v1, s[48:51], s13 offen lds
    v_mfma_f32_4x4x4_16b_bf16 v[16:19], a[56:57], a[56:57], v[16:19]
    v_mfma_f32_4x4x4_16b_bf16 v[20:23], a[58:59], a[58:59], v[20:23]
    s_add_u32 m0, s21, 24576
    s_add_u32 s13, s19, s12
    buffer_load_dwordx4 v1, s[52:55], s13 offen lds
    v_mfma_f32_16x16x32_bf16 v[124:127], v[120:123], a[56:59], v[124:127]
    v_mfma_f32_4x4x4_16b_bf16 v[16:19], a[60:61], a[60:61], v[16:19]
    s_add_u32 m0, s21, 28672
    s_add_u32 s8, s8, 1
    s_and_b32 s8, s8, 7
    buffer_load_dwordx4 v1, s[72:75], s13 offen lds
    v_mfma_f32_4x4x4_16b_bf16 v[20:23], a[62:63], a[62:63], v[20:23]
    v_mfma_f32_16x16x32_bf16 v[124:127], v[120:123], a[60:63], v[124:127]
    s_waitcnt vmcnt(12) lgkmcnt(0)
    s_barrier
    ds_read_b128 a[80:83], v8 offset:16384
    ds_read_b128 a[84:87], v9 offset:16384
    ds_read_b128 a[88:91], v10 offset:16384
    ds_read_b128 a[92:95], v11 offset:16384
    s_mul_i32 s13, s101, 176128
    s_add_u32 m0, s23, 98304
    s_add_u32 s13, s13, s18
    s_add_u32 s101, s101, 1
    s_and_b32 s101, s101, 7
    buffer_load_dwordx4 v2, s[64:67], s13 offen offset:0 lds
    v_mfma_f32_4x4x4_16b_bf16 v[16:19], a[64:65], a[64:65], v[16:19]
    v_mfma_f32_4x4x4_16b_bf16 v[20:23], a[66:67], a[66:67], v[20:23]
    buffer_load_dwordx4 v3, s[64:67], s13 offen offset:1024 lds
    v_mfma_f32_16x16x32_bf16 v[124:127], v[120:123], a[64:67], v[124:127]
    v_mfma_f32_4x4x4_16b_bf16 v[16:19], a[68:69], a[68:69], v[16:19]
    buffer_load_dwordx4 v4, s[64:67], s13 offen offset:2048 lds
    v_mfma_f32_4x4x4_16b_bf16 v[20:23], a[70:71], a[70:71], v[20:23]
    v_mfma_f32_16x16x32_bf16 v[124:127], v[120:123], a[68:71], v[124:127]
    s_mul_i32 s13, s101, 176128
    s_add_u32 m0, s23, 110592
    s_add_u32 s13, s13, s18
    s_add_u32 s101, s101, 1
    s_and_b32 s101, s101, 7
    buffer_load_dwordx4 v2, s[64:67], s13 offen offset:0 lds
    v_mfma_f32_4x4x4_16b_bf16 v[16:19], a[72:73], a[72:73], v[16:19]
    v_mfma_f32_4x4x4_16b_bf16 v[20:23], a[74:75], a[74:75], v[20:23]
    buffer_load_dwordx4 v3, s[64:67], s13 offen offset:1024 lds
    v_mfma_f32_16x16x32_bf16 v[124:127], v[120:123], a[72:75], v[124:127]
    v_mfma_f32_4x4x4_16b_bf16 v[16:19], a[76:77], a[76:77], v[16:19]
    buffer_load_dwordx4 v4, s[64:67], s13 offen offset:2048 lds
    v_mfma_f32_4x4x4_16b_bf16 v[20:23], a[78:79], a[78:79], v[20:23]
    v_mfma_f32_16x16x32_bf16 v[124:127], v[120:123], a[76:79], v[124:127]
    s_waitcnt vmcnt(12) lgkmcnt(0)
    s_barrier
    ds_read_b128 a[96:99], v8 offset:32768
    ds_read_b128 a[100:103], v9 offset:32768
    ds_read_b128 a[104:107], v10 offset:32768
    ds_read_b128 a[108:111], v11 offset:32768
    s_mul_i32 s13, s101, 176128
    s_add_u32 m0, s23, 122880
    s_add_u32 s13, s13, s18
    s_add_u32 s101, s101, 1
    s_and_b32 s101, s101, 7
    buffer_load_dwordx4 v2, s[64:67], s13 offen offset:0 lds
    v_mfma_f32_4x4x4_16b_bf16 v[16:19], a[80:81], a[80:81], v[16:19]
    v_mfma_f32_4x4x4_16b_bf16 v[20:23], a[82:83], a[82:83], v[20:23]
    buffer_load_dwordx4 v3, s[64:67], s13 offen offset:1024 lds
    v_mfma_f32_16x16x32_bf16 v[124:127], v[120:123], a[80:83], v[124:127]
    v_mfma_f32_4x4x4_16b_bf16 v[16:19], a[84:85], a[84:85], v[16:19]
    buffer_load_dwordx4 v4, s[64:67], s13 offen offset:2048 lds
    v_mfma_f32_4x4x4_16b_bf16 v[20:23], a[86:87], a[86:87], v[20:23]
    v_mfma_f32_16x16x32_bf16 v[124:127], v[120:123], a[84:87], v[124:127]
    s_mul_i32 s13, s101, 176128
    s_add_u32 m0, s23, 135168
    s_add_u32 s13, s13, s18
    s_add_u32 s101, s101, 1
    s_and_b32 s101, s101, 7
    buffer_load_dwordx4 v2, s[64:67], s13 offen offset:0 lds
    v_mfma_f32_4x4x4_16b_bf16 v[16:19], a[88:89], a[88:89], v[16:19]
    v_mfma_f32_4x4x4_16b_bf16 v[20:23], a[90:91], a[90:91], v[20:23]
    buffer_load_dwordx4 v3, s[64:67], s13 offen offset:1024 lds
    v_mfma_f32_16x16x32_bf16 v[124:127], v[120:123], a[88:91], v[124:127]
    v_mfma_f32_4x4x4_16b_bf16 v[16:19], a[92:93], a[92:93], v[16:19]
    buffer_load_dwordx4 v4, s[64:67], s13 offen offset:2048 lds
    v_mfma_f32_4x4x4_16b_bf16 v[20:23], a[94:95], a[94:95], v[20:23]
    v_mfma_f32_16x16x32_bf16 v[124:127], v[120:123], a[92:95], v[124:127]
    s_waitcnt vmcnt(12) lgkmcnt(0)
    s_barrier
    ds_read_b128 a[112:115], v8 offset:49152
    ds_read_b128 a[116:119], v9 offset:49152
    ds_read_b128 a[120:123], v10 offset:49152
    ds_read_b128 a[124:127], v11 offset:49152
    v_mfma_f32_4x4x4_16b_bf16 v[16:19], a[96:97], a[96:97], v[16:19]
    v_mfma_f32_4x4x4_16b_bf16 v[20:23], a[98:99], a[98:99], v[20:23]
    v_mfma_f32_16x16x32_bf16 v[124:127], v[120:123], a[96:99], v[124:127]
    v_mfma_f32_4x4x4_16b_bf16 v[16:19], a[100:101], a[100:101], v[16:19]
    v_mfma_f32_4x4x4_16b_bf16 v[20:23], a[102:103], a[102:103], v[20:23]
    v_mfma_f32_16x16x32_bf16 v[124:127], v[120:123], a[100:103], v[124:127]
    v_mfma_f32_4x4x4_16b_bf16 v[16:19], a[104:105], a[104:105], v[16:19]
    v_mfma_f32_4x4x4_16b_bf16 v[20:23], a[106:107], a[106:107], v[20:23]
    v_mfma_f32_16x16x32_bf16 v[124:127], v[120:123], a[104:107], v[124:127]
    v_mfma_f32_4x4x4_16b_bf16 v[16:19], a[108:109], a[108:109], v[16:19]
    v_mfma_f32_4x4x4_16b_bf16 v[20:23], a[110:111], a[110:111], v[20:23]
    v_mfma_f32_16x16x32_bf16 v[124:127], v[120:123], a[108:111], v[124:127]
    s_waitcnt lgkmcnt(0)
    v_mfma_f32_4x4x4_16b_bf16 v[16:19], a[112:113], a[112:113], v[16:19]
    v_mfma_f32_4x4x4_16b_bf16 v[20:23], a[114:115], a[114:115], v[20:23]
    s_mul_i32 s13, s101, 176128
    s_add_u32 m0, s23, 0
    s_add_u32 s13, s13, s18
    s_add_u32 s101, s101, 1
    s_and_b32 s101, s101, 7
    buffer_load_dwordx4 v2, s[64:67], s13 offen offset:0 lds
    v_mfma_f32_16x16x32_bf16 v[124:127], v[120:123], a[112:115], v[124:127]
    v_mfma_f32_4x4x4_16b_bf16 v[16:19], a[116:117], a[116:117], v[16:19]
    buffer_load_dwordx4 v3, s[64:67], s13 offen offset:1024 lds
    v_mfma_f32_4x4x4_16b_bf16 v[20:23], a[118:119], a[118:119], v[20:23]
    v_mfma_f32_16x16x32_bf16 v[124:127], v[120:123], a[116:119], v[124:127]
    buffer_load_dwordx4 v4, s[64:67], s13 offen offset:2048 lds
    v_mfma_f32_4x4x4_16b_bf16 v[16:19], a[120:121], a[120:121], v[16:19]
    v_mfma_f32_4x4x4_16b_bf16 v[20:23], a[122:123], a[122:123], v[20:23]
    s_mul_i32 s13, s101, 176128
    s_add_u32 m0, s23, 12288
    s_add_u32 s13, s13, s18
    s_add_u32 s101, s101, 1
    s_and_b32 s101, s101, 7
    buffer_load_dwordx4 v2, s[64:67], s13 offen offset:0 lds
    v_mfma_f32_16x16x32_bf16 v[124:127], v[120:123], a[120:123], v[124:127]
    v_mfma_f32_4x4x4_16b_bf16 v[16:19], a[124:125], a[124:125], v[16:19]
    buffer_load_dwordx4 v3, s[64:67], s13 offen offset:1024 lds
    v_mfma_f32_4x4x4_16b_bf16 v[20:23], a[126:127], a[126:127], v[20:23]
    v_mfma_f32_16x16x32_bf16 v[124:127], v[120:123], a[124:127], v[124:127]
    buffer_load_dwordx4 v4, s[64:67], s13 offen offset:2048 lds
    s_nop 5
    v_add_f32 v16, v16, v20
    v_add_f32 v17, v17, v21
    v_add_f32 v18, v18, v22
    v_add_f32 v19, v19, v23
    v_cndmask_b32 v16, v16, v17, s[44:45]
    v_cndmask_b32 v18, v18, v19, s[44:45]
    v_cndmask_b32 v48, v16, v18, s[46:47]
    v_mov_b32 v49, v48
    s_nop 1
    v_permlane32_swap_b32 v48, v49
    v_mul_f32 v50, 0x3b000000, v124
    v_add_f32 v48, v48, v49
    v_mul_f32 v48, 0x3b000000, v48
    v_fma_f32 v48, -v50, v50, v48
    v_max_f32 v48, 0, v48
    v_cvt_pk_bf16_f32 v48, v48, v48
    v_lshlrev_b32 v48, 16, v48
    v_add_f32 v48, 0x3727c5ac, v48
    v_cvt_pk_bf16_f32 v48, v48, v48
    v_lshlrev_b32 v48, 16, v48
    v_sqrt_f32 v48, v48
    v_cvt_pk_bf16_f32 v50, v50, v50
    v_lshlrev_b32 v50, 16, v50
    v_xor_b32 v51, 0x80000000, v50
    v_lshrrev_b32 v56, 16, v51
    v_or_b32 v56, v56, v51
    v_cndmask_b32 v56, 0, v56, s[34:35]
    v_cvt_pk_bf16_f32 v48, v48, v48
    v_lshlrev_b32 v48, 16, v48
    ds_write_b32 v60, v56
    v_rcp_f32 v6, v48
    ds_write_b32 v62, v50 offset:512
    ds_write_b32 v62, v6
    v_mov_b32 v57, v56
    v_mov_b32 v58, v56
    v_mov_b32 v59, v56
    s_lshl_b32 s44, s3, 11
    s_add_u32 s45, s44, 98304
    v_add_u32 v10, s45, v63
    v_xor_b32 v11, 64, v10
    v_add_u32 v60, s44, v63
    v_xor_b32 v61, 64, v60
    s_waitcnt vmcnt(12) lgkmcnt(0)
    s_barrier
    ds_read_b64_tr_b16 v[16:17], v12 offset:0
    ds_read_b64_tr_b16 v[18:19], v12 offset:768
    ds_read_b64_tr_b16 v[20:21], v12 offset:64
    ds_read_b64_tr_b16 v[22:23], v12 offset:832
    ds_read_b64_tr_b16 v[24:25], v12 offset:128
    ds_read_b64_tr_b16 v[26:27], v12 offset:896
    ds_read_b64_tr_b16 v[28:29], v13 offset:0
    ds_read_b64_tr_b16 v[30:31], v13 offset:768
    ds_read_b64_tr_b16 v[32:33], v13 offset:64
    ds_read_b64_tr_b16 v[34:35], v13 offset:832
    ds_read_b64_tr_b16 v[36:37], v13 offset:128
    ds_read_b64_tr_b16 v[38:39], v13 offset:896
    ds_read_b32 v52, v7 offset:60
    s_waitcnt lgkmcnt(0)
    v_readfirstlane_b32 s22, v52
    v_mfma_f32_32x32x16_bf16 v[64:79], v[16:19], a[0:3], 0
    ds_read_b64_tr_b16 v[40:41], v14 offset:0
    ds_read_b64_tr_b16 v[42:43], v14 offset:768
    v_mfma_f32_16x16x32_bf16 v[120:123], v[112:115], v[16:19], 0
    ds_read_b64_tr_b16 v[44:45], v14 offset:64
    v_mfma_f32_32x32x16_bf16 v[80:95], v[20:23], a[0:3], 0
    ds_read_b64_tr_b16 v[46:47], v14 offset:832
    v_mfma_f32_16x16x32_bf16 v[124:127], v[112:115], v[24:27], 0
    s_mul_i32 s13, s101, 176128
    s_add_u32 m0, s23, 24576
    s_add_u32 s13, s13, s18
    s_add_u32 s101, s101, 1
    s_and_b32 s101, s101, 7
    buffer_load_dwordx4 v2, s[64:67], s13 offen offset:0 lds
    v_mfma_f32_32x32x16_bf16 v[96:111], v[24:27], a[0:3], 0
    ds_read_b64_tr_b16 v[48:49], v14 offset:128
    v_mfma_f32_16x16x32_bf16 v[120:123], v[116:119], v[20:23], v[120:123]
    ds_read_b64_tr_b16 v[50:51], v14 offset:896
    v_mfma_f32_32x32x16_bf16 v[64:79], v[28:31], a[4:7], v[64:79]
    ds_read_b64_tr_b16 v[16:17], v15 offset:0
    ds_read_b64_tr_b16 v[18:19], v15 offset:768
    ds_read_b64_tr_b16 v[20:21], v15 offset:64
    v_mfma_f32_32x32x16_bf16 v[80:95], v[32:35], a[4:7], v[80:95]
    ds_read_b64_tr_b16 v[22:23], v15 offset:832
    buffer_load_dwordx4 v3, s[64:67], s13 offen offset:1024 lds
    v_mfma_f32_32x32x16_bf16 v[96:111], v[36:39], a[4:7], v[96:111]
    ds_read_b64_tr_b16 v[24:25], v15 offset:128
    ds_read_b64_tr_b16 v[26:27], v15 offset:896
    s_waitcnt lgkmcnt(6)
    v_mfma_f32_32x32x16_bf16 v[64:79], v[40:43], a[8:11], v[64:79]
    ds_read_b64_tr_b16 v[28:29], v12 offset:12288
    ds_read_b64_tr_b16 v[30:31], v12 offset:13056
    ds_read_b64_tr_b16 v[32:33], v12 offset:12352
    v_mfma_f32_32x32x16_bf16 v[80:95], v[44:47], a[8:11], v[80:95]
    ds_read_b64_tr_b16 v[34:35], v12 offset:13120
    buffer_load_dwordx4 v4, s[64:67], s13 offen offset:2048 lds
    v_mfma_f32_32x32x16_bf16 v[96:111], v[48:51], a[8:11], v[96:111]
    ds_read_b64_tr_b16 v[36:37], v12 offset:12416
    ds_read_b64_tr_b16 v[38:39], v12 offset:13184
    s_waitcnt lgkmcnt(6)
    v_mfma_f32_32x32x16_bf16 v[64:79], v[16:19], a[12:15], v[64:79]
    ds_read_b64_tr_b16 v[40:41], v13 offset:12288
    ds_read_b64_tr_b16 v[42:43], v13 offset:13056
    ds_read_b64_tr_b16 v[44:45], v13 offset:12352
    v_mfma_f32_32x32x16_bf16 v[80:95], v[20:23], a[12:15], v[80:95]
    ds_read_b64_tr_b16 v[46:47], v13 offset:13120
    s_mul_i32 s13, s101, 176128
    s_add_u32 m0, s23, 36864
    s_add_u32 s13, s13, s18
    s_add_u32 s101, s101, 1
    s_and_b32 s101, s101, 7
    buffer_load_dwordx4 v2, s[64:67], s13 offen offset:0 lds
    v_mfma_f32_32x32x16_bf16 v[96:111], v[24:27], a[12:15], v[96:111]
    ds_read_b64_tr_b16 v[48:49], v13 offset:12416
    ds_read_b64_tr_b16 v[50:51], v13 offset:13184
    s_waitcnt lgkmcnt(6)
    v_mfma_f32_32x32x16_bf16 v[64:79], v[28:31], a[16:19], v[64:79]
    ds_read_b64_tr_b16 v[16:17], v14 offset:12288
    ds_read_b64_tr_b16 v[18:19], v14 offset:13056
    v_mfma_f32_16x16x32_bf16 v[120:123], v[112:115], v[28:31], v[120:123]
    ds_read_b64_tr_b16 v[20:21], v14 offset:12352
    v_mfma_f32_32x32x16_bf16 v[80:95], v[32:35], a[16:19], v[80:95]
    ds_read_b64_tr_b16 v[22:23], v14 offset:13120
    buffer_load_dwordx4 v3, s[64:67], s13 offen offset:1024 lds
    v_mfma_f32_16x16x32_bf16 v[124:127], v[112:115], v[36:39], v[124:127]
    ds_read_b64_tr_b16 v[24:25], v14 offset:12416
    v_mfma_f32_32x32x16_bf16 v[96:111], v[36:39], a[16:19], v[96:111]
    ds_read_b64_tr_b16 v[26:27], v14 offset:13184
    s_waitcnt vmcnt(11)
    v_mfma_f32_16x16x32_bf16 v[120:123], v[116:119], v[32:35], v[120:123]
    s_mov_b64 exec, 1
    ds_add_u32 v7, v53 offset:8
    s_mov_b64 exec, -1
    s_waitcnt lgkmcnt(7)
    v_mfma_f32_32x32x16_bf16 v[64:79], v[40:43], a[20:23], v[64:79]
    ds_read_b64_tr_b16 v[28:29], v15 offset:12288
    ds_read_b64_tr_b16 v[30:31], v15 offset:13056
    ds_read_b64_tr_b16 v[32:33], v15 offset:12352
    v_mfma_f32_32x32x16_bf16 v[80:95], v[44:47], a[20:23], v[80:95]
    ds_read_b64_tr_b16 v[34:35], v15 offset:13120
    buffer_load_dwordx4 v4, s[64:67], s13 offen offset:2048 lds
    ds_read_b64_tr_b16 v[36:37], v15 offset:12416
    v_mfma_f32_32x32x16_bf16 v[96:111], v[48:51], a[20:23], v[96:111]
    ds_read_b32 v52, v7 offset:8
    ds_read_b64_tr_b16 v[38:39], v15 offset:13184
    s_waitcnt lgkmcnt(8)
    s_waitcnt lgkmcnt(1)
    v_readfirstlane_b32 s15, v52
    s_nop 0
    s_cmp_lt_u32 s15, 4
    s_cbranch_scc1 CS_1
CB_2:
    v_mfma_f32_32x32x16_bf16 v[64:79], v[16:19], a[24:27], v[64:79]
    ds_read_b64_tr_b16 v[40:41], v12 offset:24576
    ds_read_b64_tr_b16 v[42:43], v12 offset:25344
    ds_read_b64_tr_b16 v[44:45], v12 offset:24640
    v_mfma_f32_32x32x16_bf16 v[80:95], v[20:23], a[24:27], v[80:95]
    ds_read_b64_tr_b16 v[46:47], v12 offset:25408
    s_add_u32 m0, s45, 0
    s_add_u32 s13, s39, 7168
    buffer_load_dwordx4 v5, s[56:59], s39 offen lds
    s_add_u32 s39, s39, 16384
    s_cmp_eq_u32 s39, s100
    s_cselect_b32 s39, s33, s39
    ds_read_b64_tr_b16 v[48:49], v12 offset:24704
    v_mfma_f32_32x32x16_bf16 v[96:111], v[24:27], a[24:27], v[96:111]
    ds_read_b64_tr_b16 v[50:51], v12 offset:25472
    s_mov_b64 exec, 1
    ds_add_u32 v7, v53 offset:8
    s_mov_b64 exec, -1
    s_waitcnt lgkmcnt(7)
    v_mfma_f32_32x32x16_bf16 v[64:79], v[28:31], a[28:31], v[64:79]
    ds_read_b64_tr_b16 v[16:17], v13 offset:24576
    ds_read_b64_tr_b16 v[18:19], v13 offset:25344
    ds_read_b64_tr_b16 v[20:21], v13 offset:24640
    v_mfma_f32_32x32x16_bf16 v[80:95], v[32:35], a[28:31], v[80:95]
    ds_read_b64_tr_b16 v[22:23], v13 offset:25408
    ds_read_b32 v52, v7 offset:8
    ds_read_b64_tr_b16 v[24:25], v13 offset:24704
    v_mfma_f32_32x32x16_bf16 v[96:111], v[36:39], a[28:31], v[96:111]
    buffer_load_dwordx4 v5, s[56:59], s13 offen offset:1024 lds
    ds_read_b64_tr_b16 v[26:27], v13 offset:25472
    s_waitcnt lgkmcnt(8)
    s_waitcnt lgkmcnt(2)
    v_readfirstlane_b32 s15, v52
    s_nop 0
    s_cmp_lt_u32 s15, 8
    s_cbranch_scc1 CS_4
CB_5:
    v_mfma_f32_32x32x16_bf16 v[64:79], v[40:43], a[32:35], v[64:79]
    ds_read_b64_tr_b16 v[28:29], v14 offset:24576
    ds_read_b64_tr_b16 v[30:31], v14 offset:25344
    v_mfma_f32_16x16x32_bf16 v[120:123], v[112:115], v[40:43], v[120:123]
    ds_read_b64_tr_b16 v[32:33], v14 offset:24640
    v_mfma_f32_32x32x16_bf16 v[80:95], v[44:47], a[32:35], v[80:95]
    ds_read_b64_tr_b16 v[34:35], v14 offset:25408
    v_mfma_f32_16x16x32_bf16 v[124:127], v[112:115], v[48:51], v[124:127]
    s_add_u32 m0, s45, 8192
    s_add_u32 s13, s39, 7168
    buffer_load_dwordx4 v5, s[56:59], s39 offen lds
    s_add_u32 s39, s39, 16384
    s_cmp_eq_u32 s39, s100
    s_cselect_b32 s39, s33, s39
    v_mfma_f32_32x32x16_bf16 v[96:111], v[48:51], a[32:35], v[96:111]
    ds_read_b64_tr_b16 v[36:37], v14 offset:24704
    v_mfma_f32_16x16x32_bf16 v[120:123], v[116:119], v[44:47], v[120:123]
    ds_read_b64_tr_b16 v[38:39], v14 offset:25472
    s_waitcnt lgkmcnt(6)
    v_mfma_f32_32x32x16_bf16 v[64:79], v[16:19], a[36:39], v[64:79]
    ds_read_b64_tr_b16 v[40:41], v15 offset:24576
    ds_read_b64_tr_b16 v[42:43], v15 offset:25344
    ds_read_b64_tr_b16 v[44:45], v15 offset:24640
    v_mfma_f32_32x32x16_bf16 v[80:95], v[20:23], a[36:39], v[80:95]
    ds_read_b64_tr_b16 v[46:47], v15 offset:25408
    buffer_load_dwordx4 v5, s[56:59], s13 offen offset:1024 lds
    v_mfma_f32_32x32x16_bf16 v[96:111], v[24:27], a[36:39], v[96:111]
    ds_read_b64_tr_b16 v[48:49], v15 offset:24704
    ds_read_b64_tr_b16 v[50:51], v15 offset:25472
    s_waitcnt lgkmcnt(6)
    v_mfma_f32_32x32x16_bf16 v[64:79], v[28:31], a[40:43], v[64:79]
    ds_read_b64_tr_b16 v[16:17], v12 offset:36864
    ds_read_b64_tr_b16 v[18:19], v12 offset:37632
    v_mfma_f32_32x32x16_bf16 v[80:95], v[32:35], a[40:43], v[80:95]
    ds_read_b64_tr_b16 v[20:21], v12 offset:36928
    ds_read_b64_tr_b16 v[22:23], v12 offset:37696
    v_mfma_f32_32x32x16_bf16 v[96:111], v[36:39], a[40:43], v[96:111]
    ds_read_b64_tr_b16 v[24:25], v12 offset:36992
    ds_read_b64_tr_b16 v[26:27], v12 offset:37760
    s_waitcnt lgkmcnt(6)
    v_mfma_f32_32x32x16_bf16 v[64:79], v[40:43], a[44:47], v[64:79]
    ds_read_b64_tr_b16 v[28:29], v13 offset:36864
    ds_read_b64_tr_b16 v[30:31], v13 offset:37632
    v_mfma_f32_32x32x16_bf16 v[80:95], v[44:47], a[44:47], v[80:95]
    ds_read_b64_tr_b16 v[32:33], v13 offset:36928
    ds_read_b64_tr_b16 v[34:35], v13 offset:37696
    v_mfma_f32_32x32x16_bf16 v[96:111], v[48:51], a[44:47], v[96:111]
    ds_read_b64_tr_b16 v[36:37], v13 offset:36992
    ds_read_b64_tr_b16 v[38:39], v13 offset:37760
    s_waitcnt lgkmcnt(6)
    v_mfma_f32_32x32x16_bf16 v[64:79], v[16:19], a[48:51], v[64:79]
    ds_read_b64_tr_b16 v[40:41], v14 offset:36864
    ds_read_b64_tr_b16 v[42:43], v14 offset:37632
    v_mfma_f32_16x16x32_bf16 v[120:123], v[112:115], v[16:19], v[120:123]
    ds_read_b64_tr_b16 v[44:45], v14 offset:36928
    v_mfma_f32_32x32x16_bf16 v[80:95], v[20:23], a[48:51], v[80:95]
    ds_read_b64_tr_b16 v[46:47], v14 offset:37696
    v_mfma_f32_16x16x32_bf16 v[124:127], v[112:115], v[24:27], v[124:127]
    ds_read_b64_tr_b16 v[48:49], v14 offset:36992
    ds_read_b64_tr_b16 v[50:51], v14 offset:37760
    v_mfma_f32_32x32x16_bf16 v[96:111], v[24:27], a[48:51], v[96:111]
    s_waitcnt vmcnt(10)
    v_mfma_f32_16x16x32_bf16 v[120:123], v[116:119], v[20:23], v[120:123]
    s_mov_b64 exec, 1
    ds_add_u32 v7, v53 offset:8
    s_mov_b64 exec, -1
    s_waitcnt lgkmcnt(7)
    v_mfma_f32_32x32x16_bf16 v[64:79], v[28:31], a[52:55], v[64:79]
    ds_read_b64_tr_b16 v[16:17], v15 offset:36864
    ds_read_b64_tr_b16 v[18:19], v15 offset:37632
    ds_read_b64_tr_b16 v[20:21], v15 offset:36928
    v_mfma_f32_32x32x16_bf16 v[80:95], v[32:35], a[52:55], v[80:95]
    ds_read_b64_tr_b16 v[22:23], v15 offset:37696
    ds_read_b32 v52, v7 offset:8
    v_mfma_f32_32x32x16_bf16 v[96:111], v[36:39], a[52:55], v[96:111]
    ds_read_b64_tr_b16 v[24:25], v15 offset:36992
    ds_read_b64_tr_b16 v[26:27], v15 offset:37760
    s_waitcnt lgkmcnt(8)
    s_waitcnt lgkmcnt(2)
    v_readfirstlane_b32 s15, v52
    s_nop 0
    s_cmp_lt_u32 s15, 12
    s_cbranch_scc1 CS_7
CB_8:
    v_subrev_u32 v12, 98304, v12
    v_mfma_f32_32x32x16_bf16 v[64:79], v[40:43], a[56:59], v[64:79]
    ds_read_b64_tr_b16 v[28:29], v12 offset:0
    ds_read_b64_tr_b16 v[30:31], v12 offset:768
    v_mfma_f32_32x32x16_bf16 v[80:95], v[44:47], a[56:59], v[80:95]
    ds_read_b64_tr_b16 v[32:33], v12 offset:64
    ds_read_b64_tr_b16 v[34:35], v12 offset:832
    v_mfma_f32_32x32x16_bf16 v[96:111], v[48:51], a[56:59], v[96:111]
    ds_read_b64_tr_b16 v[36:37], v12 offset:128
    ds_read_b64_tr_b16 v[38:39], v12 offset:896
    s_waitcnt lgkmcnt(6)
    v_subrev_u32 v13, 98304, v13
    v_mfma_f32_32x32x16_bf16 v[64:79], v[16:19], a[60:63], v[64:79]
    ds_read_b64_tr_b16 v[40:41], v13 offset:0
    ds_read_b64_tr_b16 v[42:43], v13 offset:768
    v_mfma_f32_32x32x16_bf16 v[80:95], v[20:23], a[60:63], v[80:95]
    ds_read_b64_tr_b16 v[44:45], v13 offset:64
    ds_read_b64_tr_b16 v[46:47], v13 offset:832
    v_mfma_f32_32x32x16_bf16 v[96:111], v[24:27], a[60:63], v[96:111]
    ds_read_b64_tr_b16 v[48:49], v13 offset:128
    ds_read_b64_tr_b16 v[50:51], v13 offset:896
    s_waitcnt lgkmcnt(6)
    v_subrev_u32 v14, 98304, v14
    v_mfma_f32_32x32x16_bf16 v[64:79], v[28:31], a[64:67], v[64:79]
    ds_read_b64_tr_b16 v[16:17], v14 offset:0
    v_mfma_f32_16x16x32_bf16 v[120:123], v[112:115], v[28:31], v[120:123]
    ds_read_b64_tr_b16 v[18:19], v14 offset:768
    v_mfma_f32_32x32x16_bf16 v[80:95], v[32:35], a[64:67], v[80:95]
    ds_read_b64_tr_b16 v[20:21], v14 offset:64
    v_mfma_f32_16x16x32_bf16 v[124:127], v[112:115], v[36:39], v[124:127]
    ds_read_b64_tr_b16 v[22:23], v14 offset:832
    v_mfma_f32_32x32x16_bf16 v[96:111], v[36:39], a[64:67], v[96:111]
    ds_read_b64_tr_b16 v[24:25], v14 offset:128
    v_mfma_f32_16x16x32_bf16 v[120:123], v[116:119], v[32:35], v[120:123]
    ds_read_b64_tr_b16 v[26:27], v14 offset:896
    s_waitcnt lgkmcnt(6)
    v_subrev_u32 v15, 98304, v15
    v_mfma_f32_32x32x16_bf16 v[64:79], v[40:43], a[68:71], v[64:79]
    ds_read_b64_tr_b16 v[28:29], v15 offset:0
    ds_read_b64_tr_b16 v[30:31], v15 offset:768
    v_mfma_f32_32x32x16_bf16 v[80:95], v[44:47], a[68:71], v[80:95]
    ds_read_b64_tr_b16 v[32:33], v15 offset:64
    ds_read_b64_tr_b16 v[34:35], v15 offset:832
    v_mfma_f32_32x32x16_bf16 v[96:111], v[48:51], a[68:71], v[96:111]
    ds_read_b64_tr_b16 v[36:37], v15 offset:128
    ds_read_b64_tr_b16 v[38:39], v15 offset:896
    s_waitcnt lgkmcnt(6)
    v_mfma_f32_32x32x16_bf16 v[64:79], v[16:19], a[72:75], v[64:79]
    ds_read_b64_tr_b16 v[40:41], v12 offset:12288
    ds_read_b64_tr_b16 v[42:43], v12 offset:13056
    ds_read_b64_tr_b16 v[44:45], v12 offset:12352
    v_mfma_f32_32x32x16_bf16 v[80:95], v[20:23], a[72:75], v[80:95]
    ds_read_b64_tr_b16 v[46:47], v12 offset:13120
    ds_read_b64_tr_b16 v[48:49], v12 offset:12416
    ds_read_b64_tr_b16 v[50:51], v12 offset:13184
    v_mfma_f32_32x32x16_bf16 v[96:111], v[24:27], a[72:75], v[96:111]
    s_waitcnt vmcnt(4)
    s_mov_b64 exec, 1
    ds_add_u32 v7, v53 offset:8
    s_mov_b64 exec, -1
    s_waitcnt lgkmcnt(7)
    v_mfma_f32_32x32x16_bf16 v[64:79], v[28:31], a[76:79], v[64:79]
    ds_read_b64_tr_b16 v[16:17], v13 offset:12288
    ds_read_b64_tr_b16 v[18:19], v13 offset:13056
    ds_read_b64_tr_b16 v[20:21], v13 offset:12352
    v_mfma_f32_32x32x16_bf16 v[80:95], v[32:35], a[76:79], v[80:95]
    ds_read_b64_tr_b16 v[22:23], v13 offset:13120
    ds_read_b32 v52, v7 offset:8
    v_mfma_f32_32x32x16_bf16 v[96:111], v[36:39], a[76:79], v[96:111]
    ds_read_b64_tr_b16 v[24:25], v13 offset:12416
    ds_read_b64_tr_b16 v[26:27], v13 offset:13184
    s_waitcnt lgkmcnt(8)
    s_waitcnt lgkmcnt(2)
    v_readfirstlane_b32 s15, v52
    s_nop 0
    s_cmp_lt_u32 s15, 16
    s_cbranch_scc1 CS_10
CB_11:
    v_mfma_f32_32x32x16_bf16 v[64:79], v[40:43], a[80:83], v[64:79]
    ds_read_b64_tr_b16 v[28:29], v14 offset:12288
    ds_read_b64_tr_b16 v[30:31], v14 offset:13056
    v_mfma_f32_16x16x32_bf16 v[120:123], v[112:115], v[40:43], v[120:123]
    ds_read_b64_tr_b16 v[32:33], v14 offset:12352
    v_mfma_f32_32x32x16_bf16 v[80:95], v[44:47], a[80:83], v[80:95]
    ds_read_b64_tr_b16 v[34:35], v14 offset:13120
    v_mfma_f32_16x16x32_bf16 v[124:127], v[112:115], v[48:51], v[124:127]
    s_add_u32 m0, s45, 16384
    s_add_u32 s13, s39, 7168
    buffer_load_dwordx4 v5, s[56:59], s39 offen lds
    s_add_u32 s39, s39, 16384
    s_cmp_eq_u32 s39, s100
    s_cselect_b32 s39, s33, s39
    v_mfma_f32_32x32x16_bf16 v[96:111], v[48:51], a[80:83], v[96:111]
    ds_read_b64_tr_b16 v[36:37], v14 offset:12416
    v_mfma_f32_16x16x32_bf16 v[120:123], v[116:119], v[44:47], v[120:123]
    ds_read_b64_tr_b16 v[38:39], v14 offset:13184
    s_waitcnt lgkmcnt(6)
    v_mfma_f32_32x32x16_bf16 v[64:79], v[16:19], a[84:87], v[64:79]
    ds_read_b64_tr_b16 v[40:41], v15 offset:12288
    ds_read_b64_tr_b16 v[42:43], v15 offset:13056
    ds_read_b64_tr_b16 v[44:45], v15 offset:12352
    v_mfma_f32_32x32x16_bf16 v[80:95], v[20:23], a[84:87], v[80:95]
    ds_read_b64_tr_b16 v[46:47], v15 offset:13120
    buffer_load_dwordx4 v5, s[56:59], s13 offen offset:1024 lds
    v_mfma_f32_32x32x16_bf16 v[96:111], v[24:27], a[84:87], v[96:111]
    ds_read_b64_tr_b16 v[48:49], v15 offset:12416
    ds_read_b64_tr_b16 v[50:51], v15 offset:13184
    s_waitcnt lgkmcnt(6)
    v_mfma_f32_32x32x16_bf16 v[64:79], v[28:31], a[88:91], v[64:79]
    ds_read_b64_tr_b16 v[16:17], v12 offset:24576
    ds_read_b64_tr_b16 v[18:19], v12 offset:25344
    ds_read_b64_tr_b16 v[20:21], v12 offset:24640
    v_mfma_f32_32x32x16_bf16 v[80:95], v[32:35], a[88:91], v[80:95]
    ds_read_b64_tr_b16 v[22:23], v12 offset:25408
    s_add_u32 m0, s45, 24576
    s_add_u32 s13, s39, 7168
    buffer_load_dwordx4 v5, s[56:59], s39 offen lds
    s_add_u32 s39, s39, 16384
    s_cmp_eq_u32 s39, s100
    s_cselect_b32 s39, s33, s39
    ds_read_b64_tr_b16 v[24:25], v12 offset:24704
    v_mfma_f32_32x32x16_bf16 v[96:111], v[36:39], a[88:91], v[96:111]
    ds_read_b64_tr_b16 v[26:27], v12 offset:25472
    s_mov_b64 exec, 1
    ds_add_u32 v7, v53 offset:8
    s_mov_b64 exec, -1
    s_waitcnt lgkmcnt(7)
    v_mfma_f32_32x32x16_bf16 v[64:79], v[40:43], a[92:95], v[64:79]
    ds_read_b64_tr_b16 v[28:29], v13 offset:24576
    ds_read_b64_tr_b16 v[30:31], v13 offset:25344
    ds_read_b64_tr_b16 v[32:33], v13 offset:24640
    v_mfma_f32_32x32x16_bf16 v[80:95], v[44:47], a[92:95], v[80:95]
    ds_read_b64_tr_b16 v[34:35], v13 offset:25408
    buffer_load_dwordx4 v5, s[56:59], s13 offen offset:1024 lds
    v_mfma_f32_32x32x16_bf16 v[96:111], v[48:51], a[92:95], v[96:111]
    ds_read_b64_tr_b16 v[36:37], v13 offset:24704
    ds_read_b64_tr_b16 v[38:39], v13 offset:25472
    s_waitcnt lgkmcnt(7)
    v_mfma_f32_32x32x16_bf16 v[64:79], v[16:19], a[96:99], v[64:79]
    ds_read_b64_tr_b16 v[40:41], v14 offset:24576
    ds_read_b64_tr_b16 v[42:43], v14 offset:25344
    v_mfma_f32_16x16x32_bf16 v[120:123], v[112:115], v[16:19], v[120:123]
    ds_read_b64_tr_b16 v[44:45], v14 offset:24640
    ds_read_b64_tr_b16 v[46:47], v14 offset:25408
    v_mfma_f32_32x32x16_bf16 v[80:95], v[20:23], a[96:99], v[80:95]
    ds_read_b32 v52, v7 offset:8
    ds_read_b64_tr_b16 v[48:49], v14 offset:24704
    v_mfma_f32_16x16x32_bf16 v[124:127], v[112:115], v[24:27], v[124:127]
    s_waitcnt vmcnt(6)
    ds_read_b64_tr_b16 a[0:1], v10 offset:0
    ds_read_b64_tr_b16 v[50:51], v14 offset:25472
    v_mfma_f32_32x32x16_bf16 v[96:111], v[24:27], a[96:99], v[96:111]
    ds_read_b64_tr_b16 a[2:3], v10 offset:1024
    ds_read_b64_tr_b16 a[4:5], v11 offset:0
    v_mfma_f32_16x16x32_bf16 v[120:123], v[116:119], v[20:23], v[120:123]
    ds_read_b64_tr_b16 a[6:7], v11 offset:1024
    s_add_u32 m0, s45, 32768
    s_add_u32 s13, s39, 7168
    buffer_load_dwordx4 v5, s[56:59], s39 offen lds
    s_add_u32 s39, s39, 16384
    s_cmp_eq_u32 s39, s100
    s_cselect_b32 s39, s33, s39
    s_waitcnt lgkmcnt(11)
    s_waitcnt lgkmcnt(6)
    v_readfirstlane_b32 s15, v52
    s_nop 0
    s_cmp_lt_u32 s15, 20
    s_cbranch_scc1 CS_13
CB_14:
    v_mfma_f32_32x32x16_bf16 v[64:79], v[28:31], a[100:103], v[64:79]
    ds_read_b64_tr_b16 v[16:17], v15 offset:24576
    ds_read_b64_tr_b16 v[18:19], v15 offset:25344
    ds_read_b64_tr_b16 v[20:21], v15 offset:24640
    v_mfma_f32_32x32x16_bf16 v[80:95], v[32:35], a[100:103], v[80:95]
    ds_read_b64_tr_b16 v[22:23], v15 offset:25408
    buffer_load_dwordx4 v5, s[56:59], s13 offen offset:1024 lds
    v_mfma_f32_32x32x16_bf16 v[96:111], v[36:39], a[100:103], v[96:111]
    ds_read_b64_tr_b16 v[24:25], v15 offset:24704
    ds_read_b64_tr_b16 v[26:27], v15 offset:25472
    s_waitcnt lgkmcnt(9)
    v_mfma_f32_32x32x16_bf16 v[64:79], v[40:43], a[104:107], v[64:79]
    ds_read_b64_tr_b16 v[28:29], v12 offset:36864
    ds_read_b64_tr_b16 v[30:31], v12 offset:37632
    ds_read_b64_tr_b16 v[32:33], v12 offset:36928
    v_mfma_f32_32x32x16_bf16 v[80:95], v[44:47], a[104:107], v[80:95]
    ds_read_b64_tr_b16 v[34:35], v12 offset:37696
    s_add_u32 m0, s45, 40960
    s_add_u32 s13, s39, 7168
    buffer_load_dwordx4 v5, s[56:59], s39 offen lds
    s_add_u32 s39, s39, 16384
    s_cmp_eq_u32 s39, s100
    s_cselect_b32 s39, s33, s39
    v_mfma_f32_32x32x16_bf16 v[96:111], v[48:51], a[104:107], v[96:111]
    ds_read_b64_tr_b16 v[36:37], v12 offset:36992
    ds_read_b64_tr_b16 v[38:39], v12 offset:37760
    s_waitcnt lgkmcnt(6)
    v_mfma_f32_32x32x16_bf16 v[64:79], v[16:19], a[108:111], v[64:79]
    ds_read_b64_tr_b16 v[40:41], v13 offset:36864
    ds_read_b64_tr_b16 v[42:43], v13 offset:37632
    ds_read_b64_tr_b16 v[44:45], v13 offset:36928
    v_mfma_f32_32x32x16_bf16 v[80:95], v[20:23], a[108:111], v[80:95]
    ds_read_b64_tr_b16 v[46:47], v13 offset:37696
    buffer_load_dwordx4 v5, s[56:59], s13 offen offset:1024 lds
    v_mfma_f32_32x32x16_bf16 v[96:111], v[24:27], a[108:111], v[96:111]
    ds_read_b64_tr_b16 v[48:49], v13 offset:36992
    ds_read_b64_tr_b16 v[50:51], v13 offset:37760
    s_waitcnt lgkmcnt(6)
    v_mfma_f32_32x32x16_bf16 v[64:79], v[28:31], a[112:115], v[64:79]
    ds_read_b64_tr_b16 v[16:17], v14 offset:36864
    ds_read_b64_tr_b16 v[18:19], v14 offset:37632
    v_mfma_f32_16x16x32_bf16 v[120:123], v[112:115], v[28:31], v[120:123]
    ds_read_b64_tr_b16 v[20:21], v14 offset:36928
    ds_read_b64_tr_b16 v[22:23], v14 offset:37696
    v_mfma_f32_32x32x16_bf16 v[80:95], v[32:35], a[112:115], v[80:95]
    s_waitcnt vmcnt(8)
    ds_read_b64_tr_b16 a[8:9], v10 offset:8192
    ds_read_b64_tr_b16 v[24:25], v14 offset:36992
    v_mfma_f32_16x16x32_bf16 v[124:127], v[112:115], v[36:39], v[124:127]
    ds_read_b64_tr_b16 a[10:11], v10 offset:9216
    ds_read_b64_tr_b16 v[26:27], v14 offset:37760
    v_mfma_f32_32x32x16_bf16 v[96:111], v[36:39], a[112:115], v[96:111]
    ds_read_b64_tr_b16 a[12:13], v11 offset:8192
    ds_read_b64_tr_b16 a[14:15], v11 offset:9216
    v_mfma_f32_16x16x32_bf16 v[120:123], v[116:119], v[32:35], v[120:123]
    s_add_u32 m0, s44, 0
    s_add_u32 s13, s39, 7168
    buffer_load_dwordx4 v5, s[56:59], s39 offen lds
    s_add_u32 s39, s39, 16384
    s_cmp_eq_u32 s39, s100
    s_cselect_b32 s39, s33, s39
    s_waitcnt lgkmcnt(10)
    v_mfma_f32_32x32x16_bf16 v[64:79], v[40:43], a[116:119], v[64:79]
    ds_read_b64_tr_b16 v[28:29], v15 offset:36864
    ds_read_b64_tr_b16 v[30:31], v15 offset:37632
    ds_read_b64_tr_b16 v[32:33], v15 offset:36928
    v_mfma_f32_32x32x16_bf16 v[80:95], v[44:47], a[116:119], v[80:95]
    ds_read_b64_tr_b16 v[34:35], v15 offset:37696
    ds_read_b64_tr_b16 v[36:37], v15 offset:36992
    ds_read_b64_tr_b16 v[38:39], v15 offset:37760
    v_mfma_f32_32x32x16_bf16 v[96:111], v[48:51], a[116:119], v[96:111]
    buffer_load_dwordx4 v5, s[56:59], s13 offen offset:1024 lds
    v_cvt_pk_bf16_f32 v121, v120, v120
    v_lshlrev_b32 v121, 16, v121
    v_sub_f32 v121, v120, v121
    v_cvt_pk_bf16_f32 v120, v120, v121
    v_cvt_pk_bf16_f32 v125, v124, v124
    v_lshlrev_b32 v125, 16, v125
    v_sub_f32 v125, v124, v125
    v_cvt_pk_bf16_f32 v124, v124, v125
    ds_write_b32 v54, v120
    ds_write_b32 v54, v124 offset:1024
    s_mov_b64 exec, 1
    ds_add_u32 v7, v53 offset:12
    s_mov_b64 exec, -1
    s_waitcnt lgkmcnt(11)
    v_mfma_f32_32x32x16_bf16 v[64:79], v[16:19], a[120:123], v[64:79]
    s_add_u32 m0, s44, 8192
    s_add_u32 s13, s39, 7168
    buffer_load_dwordx4 v5, s[56:59], s39 offen lds
    s_add_u32 s39, s39, 16384
    s_cmp_eq_u32 s39, s100
    s_cselect_b32 s39, s33, s39
    v_mfma_f32_32x32x16_bf16 v[80:95], v[20:23], a[120:123], v[80:95]
    ds_read_b32 v52, v7 offset:12
    v_mfma_f32_32x32x16_bf16 v[96:111], v[24:27], a[120:123], v[96:111]
    s_waitcnt lgkmcnt(4)
    s_waitcnt lgkmcnt(0)
    v_readfirstlane_b32 s15, v52
    s_nop 0
    s_cmp_lt_u32 s15, 4
    s_cbranch_scc1 CS_16
CB_17:
    v_mfma_f32_32x32x16_bf16 v[64:79], v[28:31], a[124:127], v[64:79]
    ds_read_b128 v[40:43], v55 offset:0
    ds_read_b128 v[44:47], v55 offset:512
    v_mfma_f32_32x32x16_bf16 v[80:95], v[32:35], a[124:127], v[80:95]
    ds_read_b128 v[48:51], v55 offset:1024
    v_mfma_f32_32x32x16_bf16 v[96:111], v[36:39], a[124:127], v[96:111]
    buffer_load_dwordx4 v5, s[56:59], s13 offen offset:1024 lds
    s_waitcnt lgkmcnt(0)
    v_mfma_f32_32x32x16_bf16 v[64:79], v[40:43], v[56:59], v[64:79]
    v_mfma_f32_32x32x16_bf16 v[80:95], v[44:47], v[56:59], v[80:95]
    v_mfma_f32_32x32x16_bf16 v[96:111], v[48:51], v[56:59], v[96:111]
    s_lshl_b32 s14, s10, 10
    s_add_u32 s14, s14, s30
    s_nop 7
    v_pk_mul_f32 v[64:65], v[64:65], v[6:7] op_sel_hi:[1,0]
    v_pk_mul_f32 v[66:67], v[66:67], v[6:7] op_sel_hi:[1,0]
    v_pk_mul_f32 v[68:69], v[68:69], v[6:7] op_sel_hi:[1,0]
    v_pk_mul_f32 v[70:71], v[70:71], v[6:7] op_sel_hi:[1,0]
    v_pk_mul_f32 v[72:73], v[72:73], v[6:7] op_sel_hi:[1,0]
    v_pk_mul_f32 v[74:75], v[74:75], v[6:7] op_sel_hi:[1,0]
    v_pk_mul_f32 v[76:77], v[76:77], v[6:7] op_sel_hi:[1,0]
    v_pk_mul_f32 v[78:79], v[78:79], v[6:7] op_sel_hi:[1,0]
    v_cvt_pk_bf16_f32 v64, v64, v65
    v_cvt_pk_bf16_f32 v65, v66, v67
    v_cvt_pk_bf16_f32 v66, v68, v69
    v_cvt_pk_bf16_f32 v67, v70, v71
    v_cvt_pk_bf16_f32 v68, v72, v73
    v_cvt_pk_bf16_f32 v69, v74, v75
    v_cvt_pk_bf16_f32 v70, v76, v77
    v_cvt_pk_bf16_f32 v71, v78, v79
    v_pk_max_i16 v64, v64, 0
    v_pk_max_i16 v65, v65, 0
    v_pk_max_i16 v66, v66, 0
    v_pk_max_i16 v67, v67, 0
    v_pk_max_i16 v68, v68, 0
    v_pk_max_i16 v69, v69, 0
    v_pk_max_i16 v70, v70, 0
    v_pk_max_i16 v71, v71, 0
    buffer_store_dwordx4 v[64:67], v0, s[60:63], s14 offen offset:0 sc1
    buffer_store_dwordx4 v[68:71], v0, s[60:63], s14 offen offset:1024 sc1
    v_pk_mul_f32 v[80:81], v[80:81], v[6:7] op_sel_hi:[1,0]
    v_pk_mul_f32 v[82:83], v[82:83], v[6:7] op_sel_hi:[1,0]
    v_pk_mul_f32 v[84:85], v[84:85], v[6:7] op_sel_hi:[1,0]
    v_pk_mul_f32 v[86:87], v[86:87], v[6:7] op_sel_hi:[1,0]
    v_pk_mul_f32 v[88:89], v[88:89], v[6:7] op_sel_hi:[1,0]
    v_pk_mul_f32 v[90:91], v[90:91], v[6:7] op_sel_hi:[1,0]
    v_pk_mul_f32 v[92:93], v[92:93], v[6:7] op_sel_hi:[1,0]
    v_pk_mul_f32 v[94:95], v[94:95], v[6:7] op_sel_hi:[1,0]
    v_cvt_pk_bf16_f32 v80, v80, v81
    v_cvt_pk_bf16_f32 v81, v82, v83
    v_cvt_pk_bf16_f32 v82, v84, v85
    v_cvt_pk_bf16_f32 v83, v86, v87
    v_cvt_pk_bf16_f32 v84, v88, v89
    v_cvt_pk_bf16_f32 v85, v90, v91
    v_cvt_pk_bf16_f32 v86, v92, v93
    v_cvt_pk_bf16_f32 v87, v94, v95
    v_pk_max_i16 v80, v80, 0
    v_pk_max_i16 v81, v81, 0
    v_pk_max_i16 v82, v82, 0
    v_pk_max_i16 v83, v83, 0
    v_pk_max_i16 v84, v84, 0
    v_pk_max_i16 v85, v85, 0
    v_pk_max_i16 v86, v86, 0
    v_pk_max_i16 v87, v87, 0
    buffer_store_dwordx4 v[80:83], v0, s[60:63], s14 offen offset:2048 sc1
    buffer_store_dwordx4 v[84:87], v0, s[60:63], s14 offen offset:3072 sc1
    v_pk_mul_f32 v[96:97], v[96:97], v[6:7] op_sel_hi:[1,0]
    v_pk_mul_f32 v[98:99], v[98:99], v[6:7] op_sel_hi:[1,0]
    v_pk_mul_f32 v[100:101], v[100:101], v[6:7] op_sel_hi:[1,0]
    v_pk_mul_f32 v[102:103], v[102:103], v[6:7] op_sel_hi:[1,0]
    v_pk_mul_f32 v[104:105], v[104:105], v[6:7] op_sel_hi:[1,0]
    v_pk_mul_f32 v[106:107], v[106:107], v[6:7] op_sel_hi:[1,0]
    v_pk_mul_f32 v[108:109], v[108:109], v[6:7] op_sel_hi:[1,0]
    v_pk_mul_f32 v[110:111], v[110:111], v[6:7] op_sel_hi:[1,0]
    v_cvt_pk_bf16_f32 v96, v96, v97
    v_cvt_pk_bf16_f32 v97, v98, v99
    v_cvt_pk_bf16_f32 v98, v100, v101
    v_cvt_pk_bf16_f32 v99, v102, v103
    v_cvt_pk_bf16_f32 v100, v104, v105
    v_cvt_pk_bf16_f32 v101, v106, v107
    v_cvt_pk_bf16_f32 v102, v108, v109
    v_cvt_pk_bf16_f32 v103, v110, v111
    v_pk_max_i16 v96, v96, 0
    v_pk_max_i16 v97, v97, 0
    v_pk_max_i16 v98, v98, 0
    v_pk_max_i16 v99, v99, 0
    v_pk_max_i16 v100, v100, 0
    v_pk_max_i16 v101, v101, 0
    v_pk_max_i16 v102, v102, 0
    v_pk_max_i16 v103, v103, 0
    s_add_u32 s14, s14, 4096
    s_cmp_gt_u32 s5, 10
    s_cselect_b32 s14, 2130706432, s14
    buffer_store_dwordx4 v[96:99], v0, s[60:63], s14 offen offset:0 sc1
    buffer_store_dwordx4 v[100:103], v0, s[60:63], s14 offen offset:1024 sc1
    s_mov_b64 exec, 1
    ds_add_u32 v7, v53 offset:24
    s_mov_b64 exec, -1
    s_add_u32 m0, s44, 16384
    s_add_u32 s13, s39, 7168
    buffer_load_dwordx4 v5, s[56:59], s39 offen lds
    s_add_u32 s39, s39, 16384
    s_cmp_eq_u32 s39, s100
    s_cselect_b32 s39, s33, s39
    buffer_load_dwordx4 v5, s[56:59], s13 offen offset:1024 lds
    s_add_u32 m0, s44, 24576
    s_add_u32 s13, s39, 7168
    buffer_load_dwordx4 v5, s[56:59], s39 offen lds
    s_add_u32 s39, s39, 16384
    s_cmp_eq_u32 s39, s100
    s_cselect_b32 s39, s33, s39
    buffer_load_dwordx4 v5, s[56:59], s13 offen offset:1024 lds
    s_waitcnt vmcnt(20)
    ds_read_b64_tr_b16 a[16:17], v10 offset:16384
    ds_read_b64_tr_b16 a[18:19], v10 offset:17408
    ds_read_b64_tr_b16 a[20:21], v11 offset:16384
    ds_read_b64_tr_b16 a[22:23], v11 offset:17408
    s_waitcnt vmcnt(18)
    ds_read_b64_tr_b16 a[24:25], v10 offset:24576
    ds_read_b64_tr_b16 a[26:27], v10 offset:25600
    ds_read_b64_tr_b16 a[28:29], v11 offset:24576
    ds_read_b64_tr_b16 a[30:31], v11 offset:25600
    s_waitcnt vmcnt(16)
    ds_read_b64_tr_b16 a[32:33], v10 offset:32768
    ds_read_b64_tr_b16 a[34:35], v10 offset:33792
    ds_read_b64_tr_b16 a[36:37], v11 offset:32768
    ds_read_b64_tr_b16 a[38:39], v11 offset:33792
    s_waitcnt vmcnt(14)
    ds_read_b64_tr_b16 a[40:41], v10 offset:40960
    ds_read_b64_tr_b16 a[42:43], v10 offset:41984
    ds_read_b64_tr_b16 a[44:45], v11 offset:40960
    ds_read_b64_tr_b16 a[46:47], v11 offset:41984
    s_waitcnt vmcnt(12)
    ds_read_b64_tr_b16 a[48:49], v60 offset:0
    ds_read_b64_tr_b16 a[50:51], v60 offset:1024
    ds_read_b64_tr_b16 a[52:53], v61 offset:0
    ds_read_b64_tr_b16 a[54:55], v61 offset:1024
    s_waitcnt vmcnt(10)
    ds_read_b64_tr_b16 a[56:57], v60 offset:8192
    ds_read_b64_tr_b16 a[58:59], v60 offset:9216
    ds_read_b64_tr_b16 a[60:61], v61 offset:8192
    ds_read_b64_tr_b16 a[62:63], v61 offset:9216
    s_lshl_b32 s13, s4, 1
    s_lshr_b32 s12, s3, 1
    s_add_u32 s13, s13, s12
    s_lshl_b32 s13, s13, 12
    s_add_u32 s11, s13, 17825792
    s_lshl_b32 s13, s5, 1
    s_and_b32 s12, s3, 1
    s_add_u32 s13, s13, s12
    s_lshl_b32 s13, s13, 2
    s_add_u32 s11, s11, s13
    s_cmp_gt_u32 s5, 10
    s_cselect_b32 s12, 3, 5
    s_add_u32 s12, s12, s10
    s_mul_i32 s12, s12, 27
    s_lshr_b32 s12, s12, 9
    s_lshl_b32 s12, s12, 8
    s_mul_i32 s13, s10, 27
    s_lshr_b32 s13, s13, 9
    s_lshl_b32 s13, s13, 8
    v_mov_b32 v13, s13
    v_mov_b32 v12, s22
    v_writelane_b32 v13, s12, 1
    s_waitcnt vmcnt(4)
    s_mov_b64 exec, 3
    buffer_store_dword v12, v13, s[60:63], s11 offen sc1
    s_mov_b64 exec, -1
    v_mov_b32 v112, v10
    v_mov_b32 v113, v11
    v_mov_b32 v114, v60
    v_mov_b32 v115, v61
    v_mov_b32 v6, 1
    v_lshrrev_b32 v116, 2, v0
    s_mov_b32 s36, s22
    s_mov_b32 s37, s22
    s_mul_i32 s12, s3, 280
    s_add_u32 s32, s32, s12
    s_waitcnt lgkmcnt(0)
    s_mov_b32 s24, 0
SP_19:
    ds_read_b32 v117, v7 offset:20
    s_add_u32 s24, s24, 1
    s_waitcnt lgkmcnt(0)
    v_readfirstlane_b32 s15, v117
    s_cmp_gt_u32 s24, 200000
    s_cbranch_scc1 SD_20
    s_cmp_lt_u32 s15, 4
    s_cbranch_scc1 SP_19
SD_20:
    v_lshrrev_b32 v1, 4, v0
    v_and_b32 v2, 31, v1
    v_lshrrev_b32 v1, 5, v1
    v_lshlrev_b32 v3, 1, v2
    v_lshl_add_u32 v4, v1, 14, v3
    s_lshr_b32 s12, s3, 1
    s_and_b32 s13, s3, 1
    s_lshl_b32 s14, s7, 1
    s_add_u32 s14, s14, s12
    s_lshl_b32 s14, s14, 5
    s_lshl_b32 s16, s6, 7
    s_lshl_b32 s13, s13, 6
    s_add_u32 s16, s16, s13
    s_lshl_b32 s12, s4, 7
    s_add_u32 s12, s12, s14
    s_lshl_b32 s12, s12, 10
    s_add_u32 s12, s12, s16
    s_lshl_b32 s14, s14, 2
    s_add_u32 s14, s14, 147456
    v_lshlrev_b32 v1, 6, v1
    v_add_u32 v1, s14, v1
    buffer_load_ushort v118, v3, s[76:79], s16 offen
    s_lshl_b32 s16, s12, 1
    buffer_load_ushort v64, v4, s[48:51], s12 offen offset:0
    buffer_load_ushort v65, v4, s[48:51], s12 offen offset:1024
    buffer_load_ushort v66, v4, s[48:51], s12 offen offset:2048
    buffer_load_ushort v67, v4, s[48:51], s12 offen offset:3072
    s_add_u32 s12, s12, 4096
    buffer_load_ushort v68, v4, s[48:51], s12 offen offset:0
    buffer_load_ushort v69, v4, s[48:51], s12 offen offset:1024
    buffer_load_ushort v70, v4, s[48:51], s12 offen offset:2048
    buffer_load_ushort v71, v4, s[48:51], s12 offen offset:3072
    s_add_u32 s12, s12, 4096
    buffer_load_ushort v72, v4, s[48:51], s12 offen offset:0
    buffer_load_ushort v73, v4, s[48:51], s12 offen offset:1024
    buffer_load_ushort v74, v4, s[48:51], s12 offen offset:2048
    buffer_load_ushort v75, v4, s[48:51], s12 offen offset:3072
    s_add_u32 s12, s12, 4096
    buffer_load_ushort v76, v4, s[48:51], s12 offen offset:0
    buffer_load_ushort v77, v4, s[48:51], s12 offen offset:1024
    buffer_load_ushort v78, v4, s[48:51], s12 offen offset:2048
    buffer_load_ushort v79, v4, s[48:51], s12 offen offset:3072
    ds_read_b128 v[80:83], v1 offset:512
    ds_read_b128 v[96:99], v1 offset:0
    ds_read_b128 v[84:87], v1 offset:528
    ds_read_b128 v[100:103], v1 offset:16
    ds_read_b128 v[88:91], v1 offset:544
    ds_read_b128 v[104:107], v1 offset:32
    ds_read_b128 v[92:95], v1 offset:560
    ds_read_b128 v[108:111], v1 offset:48
    s_add_u32 m0, s44, 32768
    s_add_u32 s13, s39, 7168
    buffer_load_dwordx4 v5, s[56:59], s39 offen lds
    s_add_u32 s39, s39, 16384
    s_cmp_eq_u32 s39, s100
    s_cselect_b32 s39, s33, s39
    buffer_load_dwordx4 v5, s[56:59], s13 offen offset:1024 lds
    s_add_u32 m0, s44, 40960
    s_add_u32 s13, s39, 7168
    buffer_load_dwordx4 v5, s[56:59], s39 offen lds
    s_add_u32 s39, s39, 16384
    s_cmp_eq_u32 s39, s100
    s_cselect_b32 s39, s33, s39
    buffer_load_dwordx4 v5, s[56:59], s13 offen offset:1024 lds
    s_add_u32 m0, s45, 0
    s_add_u32 s13, s39, 7168
    buffer_load_dwordx4 v5, s[56:59], s39 offen lds
    s_add_u32 s39, s39, 16384
    s_cmp_eq_u32 s39, s100
    s_cselect_b32 s39, s33, s39
    buffer_load_dwordx4 v5, s[56:59], s13 offen offset:1024 lds
    s_add_u32 m0, s45, 8192
    s_add_u32 s13, s39, 7168
    buffer_load_dwordx4 v5, s[56:59], s39 offen lds
    s_add_u32 s39, s39, 16384
    s_cmp_eq_u32 s39, s100
    s_cselect_b32 s39, s33, s39
    buffer_load_dwordx4 v5, s[56:59], s13 offen offset:1024 lds
    s_add_u32 m0, s45, 16384
    s_add_u32 s13, s39, 7168
    buffer_load_dwordx4 v5, s[56:59], s39 offen lds
    s_add_u32 s39, s39, 16384
    s_cmp_eq_u32 s39, s100
    s_cselect_b32 s39, s33, s39
    buffer_load_dwordx4 v5, s[56:59], s13 offen offset:1024 lds
    s_add_u32 m0, s45, 24576
    s_add_u32 s13, s39, 7168
    buffer_load_dwordx4 v5, s[56:59], s39 offen lds
    s_add_u32 s39, s39, 16384
    s_cmp_eq_u32 s39, s100
    s_cselect_b32 s39, s33, s39
    buffer_load_dwordx4 v5, s[56:59], s13 offen offset:1024 lds
    s_add_u32 m0, s45, 32768
    s_add_u32 s13, s39, 7168
    buffer_load_dwordx4 v5, s[56:59], s39 offen lds
    s_add_u32 s39, s39, 16384
    s_cmp_eq_u32 s39, s100
    s_cselect_b32 s39, s33, s39
    buffer_load_dwordx4 v5, s[56:59], s13 offen offset:1024 lds
    s_add_u32 m0, s45, 40960
    s_add_u32 s13, s39, 7168
    buffer_load_dwordx4 v5, s[56:59], s39 offen lds
    s_add_u32 s39, s39, 16384
    s_cmp_eq_u32 s39, s100
    s_cselect_b32 s39, s33, s39
    buffer_load_dwordx4 v5, s[56:59], s13 offen offset:1024 lds
    s_add_u32 m0, s44, 0
    s_add_u32 s13, s39, 7168
    buffer_load_dwordx4 v5, s[56:59], s39 offen lds
    s_add_u32 s39, s39, 16384
    s_cmp_eq_u32 s39, s100
    s_cselect_b32 s39, s33, s39
    buffer_load_dwordx4 v5, s[56:59], s13 offen offset:1024 lds
    s_buffer_load_dwordx8 s[92:99], s[60:63], s32 glc
    s_buffer_load_dwordx2 s[46:47], s[60:63], s32 offset:32 glc
    s_lshr_b32 s12, s3, 1
    s_mul_i32 s12, s12, 153600
    s_sub_u32 s13, 153600, s12
    v_add_u32 v1, s12, v0
    v_add_u32 v2, s13, v0
    s_mul_i32 s12, s3, 19456
    s_add_u32 s33, s31, s12
    s_add_u32 s17, s17, s33
    s_add_u32 s100, s33, 19456
    s_waitcnt lgkmcnt(0)
    s_cmp_eq_u32 s3, 3
    s_cselect_b64 s[46:47], s[46:47], s[36:37]
    s_xor_b64 s[92:93], s[92:93], s[36:37]
    s_xor_b64 s[94:95], s[94:95], s[36:37]
    s_xor_b64 s[96:97], s[96:97], s[36:37]
    s_xor_b64 s[98:99], s[98:99], s[36:37]
    s_xor_b64 s[46:47], s[46:47], s[36:37]
    s_or_b64 s[92:93], s[92:93], s[94:95]
    s_or_b64 s[92:93], s[92:93], s[96:97]
    s_or_b64 s[92:93], s[92:93], s[98:99]
    s_or_b64 s[92:93], s[92:93], s[46:47]
    s_cbranch_scc1 PL_21
PD_22:
    buffer_load_dwordx4 v[40:43], v1, s[60:63], s17 offen sc1
    buffer_load_dwordx4 v[44:47], v2, s[60:63], s17 offen sc1
    s_add_u32 s17, s17, 1024
    s_cmp_eq_u32 s17, s100
    s_cselect_b32 s17, s33, s17
    buffer_load_dwordx4 v[48:51], v1, s[60:63], s17 offen sc1
    buffer_load_dwordx4 v[52:55], v2, s[60:63], s17 offen sc1
    s_add_u32 s17, s17, 1024
    s_cmp_eq_u32 s17, s100
    s_cselect_b32 s17, s33, s17
    buffer_load_dwordx4 v[56:59], v1, s[60:63], s17 offen sc1
    buffer_load_dwordx4 v[60:63], v2, s[60:63], s17 offen sc1
    s_add_u32 s17, s17, 1024
    s_cmp_eq_u32 s17, s100
    s_cselect_b32 s17, s33, s17
    buffer_load_dwordx4 v[8:11], v1, s[60:63], s17 offen sc1
    buffer_load_dwordx4 v[12:15], v2, s[60:63], s17 offen sc1
    s_add_u32 s17, s17, 1024
    s_cmp_eq_u32 s17, s100
    s_cselect_b32 s17, s33, s17
    s_waitcnt vmcnt(26)
    v_lshlrev_b32 v118, 16, v118
    v_lshlrev_b32 v64, 16, v64
    v_lshlrev_b32 v65, 16, v65
    v_lshlrev_b32 v66, 16, v66
    v_lshlrev_b32 v67, 16, v67
    v_lshlrev_b32 v68, 16, v68
    v_lshlrev_b32 v69, 16, v69
    v_lshlrev_b32 v70, 16, v70
    v_lshlrev_b32 v71, 16, v71
    v_lshlrev_b32 v72, 16, v72
    v_lshlrev_b32 v73, 16, v73
    v_lshlrev_b32 v74, 16, v74
    v_lshlrev_b32 v75, 16, v75
    v_lshlrev_b32 v76, 16, v76
    v_lshlrev_b32 v77, 16, v77
    v_lshlrev_b32 v78, 16, v78
    v_lshlrev_b32 v79, 16, v79
    v_pk_add_f32 v[80:81], v[64:65], v[80:81] neg_lo:[0,1] neg_hi:[0,1]
    v_pk_add_f32 v[82:83], v[66:67], v[82:83] neg_lo:[0,1] neg_hi:[0,1]
    v_pk_add_f32 v[84:85], v[68:69], v[84:85] neg_lo:[0,1] neg_hi:[0,1]
    v_pk_add_f32 v[86:87], v[70:71], v[86:87] neg_lo:[0,1] neg_hi:[0,1]
    v_pk_add_f32 v[88:89], v[72:73], v[88:89] neg_lo:[0,1] neg_hi:[0,1]
    v_pk_add_f32 v[90:91], v[74:75], v[90:91] neg_lo:[0,1] neg_hi:[0,1]
    v_pk_add_f32 v[92:93], v[76:77], v[92:93] neg_lo:[0,1] neg_hi:[0,1]
    v_pk_add_f32 v[94:95], v[78:79], v[94:95] neg_lo:[0,1] neg_hi:[0,1]
    v_cvt_pk_bf16_f32 v81, v80, v81
    v_lshlrev_b32 v80, 16, v81
    v_and_b32 v81, s25, v81
    v_cvt_pk_bf16_f32 v83, v82, v83
    v_lshlrev_b32 v82, 16, v83
    v_and_b32 v83, s25, v83
    v_cvt_pk_bf16_f32 v85, v84, v85
    v_lshlrev_b32 v84, 16, v85
    v_and_b32 v85, s25, v85
    v_cvt_pk_bf16_f32 v87, v86, v87
    v_lshlrev_b32 v86, 16, v87
    v_and_b32 v87, s25, v87
    v_cvt_pk_bf16_f32 v89, v88, v89
    v_lshlrev_b32 v88, 16, v89
    v_and_b32 v89, s25, v89
    v_cvt_pk_bf16_f32 v91, v90, v91
    v_lshlrev_b32 v90, 16, v91
    v_and_b32 v91, s25, v91
    v_cvt_pk_bf16_f32 v93, v92, v93
    v_lshlrev_b32 v92, 16, v93
    v_and_b32 v93, s25, v93
    v_cvt_pk_bf16_f32 v95, v94, v95
    v_lshlrev_b32 v94, 16, v95
    v_and_b32 v95, s25, v95
    v_pk_mul_f32 v[80:81], v[80:81], v[96:97]
    v_pk_mul_f32 v[82:83], v[82:83], v[98:99]
    v_pk_mul_f32 v[84:85], v[84:85], v[100:101]
    v_pk_mul_f32 v[86:87], v[86:87], v[102:103]
    v_pk_mul_f32 v[88:89], v[88:89], v[104:105]
    v_pk_mul_f32 v[90:91], v[90:91], v[106:107]
    v_pk_mul_f32 v[92:93], v[92:93], v[108:109]
    v_pk_mul_f32 v[94:95], v[94:95], v[110:111]
    v_cvt_pk_bf16_f32 v81, v80, v81
    v_lshlrev_b32 v80, 16, v81
    v_and_b32 v81, s25, v81
    v_cvt_pk_bf16_f32 v83, v82, v83
    v_lshlrev_b32 v82, 16, v83
    v_and_b32 v83, s25, v83
    v_cvt_pk_bf16_f32 v85, v84, v85
    v_lshlrev_b32 v84, 16, v85
    v_and_b32 v85, s25, v85
    v_cvt_pk_bf16_f32 v87, v86, v87
    v_lshlrev_b32 v86, 16, v87
    v_and_b32 v87, s25, v87
    v_cvt_pk_bf16_f32 v89, v88, v89
    v_lshlrev_b32 v88, 16, v89
    v_and_b32 v89, s25, v89
    v_cvt_pk_bf16_f32 v91, v90, v91
    v_lshlrev_b32 v90, 16, v91
    v_and_b32 v91, s25, v91
    v_cvt_pk_bf16_f32 v93, v92, v93
    v_lshlrev_b32 v92, 16, v93
    v_and_b32 v93, s25, v93
    v_cvt_pk_bf16_f32 v95, v94, v95
    v_lshlrev_b32 v94, 16, v95
    v_and_b32 v95, s25, v95
    v_pk_mul_f32 v[80:81], v[80:81], v[118:119] op_sel_hi:[1,0]
    v_pk_mul_f32 v[82:83], v[82:83], v[118:119] op_sel_hi:[1,0]
    v_pk_mul_f32 v[84:85], v[84:85], v[118:119] op_sel_hi:[1,0]
    v_pk_mul_f32 v[86:87], v[86:87], v[118:119] op_sel_hi:[1,0]
    v_pk_mul_f32 v[88:89], v[88:89], v[118:119] op_sel_hi:[1,0]
    v_pk_mul_f32 v[90:91], v[90:91], v[118:119] op_sel_hi:[1,0]
    v_pk_mul_f32 v[92:93], v[92:93], v[118:119] op_sel_hi:[1,0]
    v_pk_mul_f32 v[94:95], v[94:95], v[118:119] op_sel_hi:[1,0]
    v_cvt_pk_bf16_f32 v81, v80, v81
    v_lshlrev_b32 v80, 16, v81
    v_and_b32 v81, s25, v81
    v_cvt_pk_bf16_f32 v83, v82, v83
    v_lshlrev_b32 v82, 16, v83
    v_and_b32 v83, s25, v83
    v_cvt_pk_bf16_f32 v85, v84, v85
    v_lshlrev_b32 v84, 16, v85
    v_and_b32 v85, s25, v85
    v_cvt_pk_bf16_f32 v87, v86, v87
    v_lshlrev_b32 v86, 16, v87
    v_and_b32 v87, s25, v87
    v_cvt_pk_bf16_f32 v89, v88, v89
    v_lshlrev_b32 v88, 16, v89
    v_and_b32 v89, s25, v89
    v_cvt_pk_bf16_f32 v91, v90, v91
    v_lshlrev_b32 v90, 16, v91
    v_and_b32 v91, s25, v91
    v_cvt_pk_bf16_f32 v93, v92, v93
    v_lshlrev_b32 v92, 16, v93
    v_and_b32 v93, s25, v93
    v_cvt_pk_bf16_f32 v95, v94, v95
    v_lshlrev_b32 v94, 16, v95
    v_and_b32 v95, s25, v95
    v_pk_add_f32 v[64:65], v[64:65], v[80:81]
    v_pk_add_f32 v[66:67], v[66:67], v[82:83]
    v_pk_add_f32 v[68:69], v[68:69], v[84:85]
    v_pk_add_f32 v[70:71], v[70:71], v[86:87]
    v_pk_add_f32 v[72:73], v[72:73], v[88:89]
    v_pk_add_f32 v[74:75], v[74:75], v[90:91]
    v_pk_add_f32 v[76:77], v[76:77], v[92:93]
    v_pk_add_f32 v[78:79], v[78:79], v[94:95]
    ds_read_b64_tr_b16 a[64:65], v114 offset:16384
    ds_read_b64_tr_b16 a[66:67], v114 offset:17408
    ds_read_b64_tr_b16 a[68:69], v115 offset:16384
    ds_read_b64_tr_b16 a[70:71], v115 offset:17408
    ds_read_b64_tr_b16 a[72:73], v114 offset:24576
    ds_read_b64_tr_b16 a[74:75], v114 offset:25600
    ds_read_b64_tr_b16 a[76:77], v115 offset:24576
    ds_read_b64_tr_b16 a[78:79], v115 offset:25600
    s_waitcnt vmcnt(24)
    ds_read_b64_tr_b16 a[80:81], v114 offset:32768
    ds_read_b64_tr_b16 a[82:83], v114 offset:33792
    ds_read_b64_tr_b16 a[84:85], v115 offset:32768
    ds_read_b64_tr_b16 a[86:87], v115 offset:33792
    s_waitcnt vmcnt(22)
    ds_read_b64_tr_b16 a[88:89], v114 offset:40960
    ds_read_b64_tr_b16 a[90:91], v114 offset:41984
    ds_read_b64_tr_b16 a[92:93], v115 offset:40960
    ds_read_b64_tr_b16 a[94:95], v115 offset:41984
    s_waitcnt vmcnt(20)
    ds_read_b64_tr_b16 a[96:97], v112 offset:0
    ds_read_b64_tr_b16 a[98:99], v112 offset:1024
    ds_read_b64_tr_b16 a[100:101], v113 offset:0
    ds_read_b64_tr_b16 a[102:103], v113 offset:1024
    s_waitcnt vmcnt(18)
    ds_read_b64_tr_b16 a[104:105], v112 offset:8192
    ds_read_b64_tr_b16 a[106:107], v112 offset:9216
    ds_read_b64_tr_b16 a[108:109], v113 offset:8192
    ds_read_b64_tr_b16 a[110:111], v113 offset:9216
    s_waitcnt vmcnt(16)
    ds_read_b64_tr_b16 a[112:113], v112 offset:16384
    ds_read_b64_tr_b16 a[114:115], v112 offset:17408
    ds_read_b64_tr_b16 a[116:117], v113 offset:16384
    ds_read_b64_tr_b16 a[118:119], v113 offset:17408
    s_waitcnt vmcnt(14)
    ds_read_b64_tr_b16 a[120:121], v112 offset:24576
    ds_read_b64_tr_b16 a[122:123], v112 offset:25600
    ds_read_b64_tr_b16 a[124:125], v113 offset:24576
    ds_read_b64_tr_b16 a[126:127], v113 offset:25600
    s_waitcnt vmcnt(12)
    ds_read_b64_tr_b16 v[16:17], v112 offset:32768
    ds_read_b64_tr_b16 v[18:19], v112 offset:33792
    ds_read_b64_tr_b16 v[20:21], v113 offset:32768
    ds_read_b64_tr_b16 v[22:23], v113 offset:33792
    s_waitcnt vmcnt(10)
    ds_read_b64_tr_b16 v[24:25], v112 offset:40960
    ds_read_b64_tr_b16 v[26:27], v112 offset:41984
    ds_read_b64_tr_b16 v[28:29], v113 offset:40960
    ds_read_b64_tr_b16 v[30:31], v113 offset:41984
    s_waitcnt vmcnt(8)
    ds_read_b64_tr_b16 v[32:33], v114 offset:0
    ds_read_b64_tr_b16 v[34:35], v114 offset:1024
    ds_read_b64_tr_b16 v[36:37], v115 offset:0
    ds_read_b64_tr_b16 v[38:39], v115 offset:1024
    s_waitcnt lgkmcnt(0)
    s_mov_b64 exec, 1
    ds_add_u32 v7, v6 offset:16
    s_mov_b64 exec, -1
    s_waitcnt vmcnt(6)
    v_mfma_f32_32x32x16_bf16 v[64:79], v[40:43], a[0:3], v[64:79]
    v_mfma_f32_32x32x16_bf16 v[80:95], v[40:43], a[4:7], 0
    v_mfma_f32_32x32x16_bf16 v[96:111], v[44:47], a[0:3], 0
    v_mfma_f32_32x32x16_bf16 v[112:127], v[44:47], a[4:7], 0
    buffer_load_dwordx4 v[40:43], v1, s[60:63], s17 offen sc1
    buffer_load_dwordx4 v[44:47], v2, s[60:63], s17 offen sc1
    s_add_u32 s17, s17, 1024
    s_cmp_eq_u32 s17, s100
    s_cselect_b32 s17, s33, s17
    buffer_load_dwordx4 a[0:3], v1, s[60:63], s17 offen sc1
    buffer_load_dwordx4 a[4:7], v2, s[60:63], s17 offen sc1
    s_add_u32 s17, s17, 1024
    s_cmp_eq_u32 s17, s100
    s_cselect_b32 s17, s33, s17
    s_waitcnt vmcnt(8)
    v_mfma_f32_32x32x16_bf16 v[64:79], v[48:51], a[8:11], v[64:79]
    v_mfma_f32_32x32x16_bf16 v[80:95], v[48:51], a[12:15], v[80:95]
    v_mfma_f32_32x32x16_bf16 v[96:111], v[52:55], a[8:11], v[96:111]
    v_mfma_f32_32x32x16_bf16 v[112:127], v[52:55], a[12:15], v[112:127]
    buffer_load_dwordx4 v[48:51], v1, s[60:63], s17 offen sc1
    buffer_load_dwordx4 v[52:55], v2, s[60:63], s17 offen sc1
    s_add_u32 s17, s17, 1024
    s_cmp_eq_u32 s17, s100
    s_cselect_b32 s17, s33, s17
    s_waitcnt vmcnt(8)
    v_mfma_f32_32x32x16_bf16 v[64:79], v[56:59], a[16:19], v[64:79]
    v_mfma_f32_32x32x16_bf16 v[80:95], v[56:59], a[20:23], v[80:95]
    v_mfma_f32_32x32x16_bf16 v[96:111], v[60:63], a[16:19], v[96:111]
    v_mfma_f32_32x32x16_bf16 v[112:127], v[60:63], a[20:23], v[112:127]
    buffer_load_dwordx4 a[8:11], v1, s[60:63], s17 offen sc1
    buffer_load_dwordx4 a[12:15], v2, s[60:63], s17 offen sc1
    s_add_u32 s17, s17, 1024
    s_cmp_eq_u32 s17, s100
    s_cselect_b32 s17, s33, s17
    s_waitcnt vmcnt(8)
    v_mfma_f32_32x32x16_bf16 v[64:79], v[8:11], a[24:27], v[64:79]
    v_mfma_f32_32x32x16_bf16 v[80:95], v[8:11], a[28:31], v[80:95]
    v_mfma_f32_32x32x16_bf16 v[96:111], v[12:15], a[24:27], v[96:111]
    v_mfma_f32_32x32x16_bf16 v[112:127], v[12:15], a[28:31], v[112:127]
    buffer_load_dwordx4 v[56:59], v1, s[60:63], s17 offen sc1
    buffer_load_dwordx4 v[60:63], v2, s[60:63], s17 offen sc1
    s_add_u32 s17, s17, 1024
    s_cmp_eq_u32 s17, s100
    s_cselect_b32 s17, s33, s17
    s_waitcnt vmcnt(8)
    v_mfma_f32_32x32x16_bf16 v[64:79], v[40:43], a[32:35], v[64:79]
    v_mfma_f32_32x32x16_bf16 v[80:95], v[40:43], a[36:39], v[80:95]
    v_mfma_f32_32x32x16_bf16 v[96:111], v[44:47], a[32:35], v[96:111]
    v_mfma_f32_32x32x16_bf16 v[112:127], v[44:47], a[36:39], v[112:127]
    buffer_load_dwordx4 a[16:19], v1, s[60:63], s17 offen sc1
    buffer_load_dwordx4 a[20:23], v2, s[60:63], s17 offen sc1
    s_add_u32 s17, s17, 1024
    s_cmp_eq_u32 s17, s100
    s_cselect_b32 s17, s33, s17
    s_waitcnt vmcnt(8)
    v_mfma_f32_32x32x16_bf16 v[64:79], a[0:3], a[40:43], v[64:79]
    v_mfma_f32_32x32x16_bf16 v[80:95], a[0:3], a[44:47], v[80:95]
    v_mfma_f32_32x32x16_bf16 v[96:111], a[4:7], a[40:43], v[96:111]
    v_mfma_f32_32x32x16_bf16 v[112:127], a[4:7], a[44:47], v[112:127]
    buffer_load_dwordx4 v[8:11], v1, s[60:63], s17 offen sc1
    buffer_load_dwordx4 v[12:15], v2, s[60:63], s17 offen sc1
    s_add_u32 s17, s17, 1024
    s_cmp_eq_u32 s17, s100
    s_cselect_b32 s17, s33, s17
    s_waitcnt vmcnt(8)
    v_mfma_f32_32x32x16_bf16 v[64:79], v[48:51], a[48:51], v[64:79]
    v_mfma_f32_32x32x16_bf16 v[80:95], v[48:51], a[52:55], v[80:95]
    v_mfma_f32_32x32x16_bf16 v[96:111], v[52:55], a[48:51], v[96:111]
    v_mfma_f32_32x32x16_bf16 v[112:127], v[52:55], a[52:55], v[112:127]
    buffer_load_dwordx4 a[24:27], v1, s[60:63], s17 offen sc1
    buffer_load_dwordx4 a[28:31], v2, s[60:63], s17 offen sc1
    s_add_u32 s17, s17, 1024
    s_cmp_eq_u32 s17, s100
    s_cselect_b32 s17, s33, s17
    s_waitcnt vmcnt(8)
    v_mfma_f32_32x32x16_bf16 v[64:79], a[8:11], a[56:59], v[64:79]
    v_mfma_f32_32x32x16_bf16 v[80:95], a[8:11], a[60:63], v[80:95]
    v_mfma_f32_32x32x16_bf16 v[96:111], a[12:15], a[56:59], v[96:111]
    v_mfma_f32_32x32x16_bf16 v[112:127], a[12:15], a[60:63], v[112:127]
    buffer_load_dwordx4 v[40:43], v1, s[60:63], s17 offen sc1
    buffer_load_dwordx4 v[44:47], v2, s[60:63], s17 offen sc1
    s_add_u32 s17, s17, 1024
    s_cmp_eq_u32 s17, s100
    s_cselect_b32 s17, s33, s17
    s_waitcnt vmcnt(8)
    v_mfma_f32_32x32x16_bf16 v[64:79], v[56:59], a[64:67], v[64:79]
    v_mfma_f32_32x32x16_bf16 v[80:95], v[56:59], a[68:71], v[80:95]
    v_mfma_f32_32x32x16_bf16 v[96:111], v[60:63], a[64:67], v[96:111]
    v_mfma_f32_32x32x16_bf16 v[112:127], v[60:63], a[68:71], v[112:127]
    buffer_load_dwordx4 a[32:35], v1, s[60:63], s17 offen sc1
    buffer_load_dwordx4 a[36:39], v2, s[60:63], s17 offen sc1
    s_add_u32 s17, s17, 1024
    s_cmp_eq_u32 s17, s100
    s_cselect_b32 s17, s33, s17
    s_waitcnt vmcnt(8)
    v_mfma_f32_32x32x16_bf16 v[64:79], a[16:19], a[72:75], v[64:79]
    v_mfma_f32_32x32x16_bf16 v[80:95], a[16:19], a[76:79], v[80:95]
    v_mfma_f32_32x32x16_bf16 v[96:111], a[20:23], a[72:75], v[96:111]
    v_mfma_f32_32x32x16_bf16 v[112:127], a[20:23], a[76:79], v[112:127]
    buffer_load_dwordx4 a[0:3], v1, s[60:63], s17 offen sc1
    buffer_load_dwordx4 a[4:7], v2, s[60:63], s17 offen sc1
    s_add_u32 s17, s17, 1024
    s_cmp_eq_u32 s17, s100
    s_cselect_b32 s17, s33, s17
    s_waitcnt vmcnt(8)
    v_mfma_f32_32x32x16_bf16 v[64:79], v[8:11], a[80:83], v[64:79]
    v_mfma_f32_32x32x16_bf16 v[80:95], v[8:11], a[84:87], v[80:95]
    v_mfma_f32_32x32x16_bf16 v[96:111], v[12:15], a[80:83], v[96:111]
    v_mfma_f32_32x32x16_bf16 v[112:127], v[12:15], a[84:87], v[112:127]
    buffer_load_dwordx4 a[40:43], v1, s[60:63], s17 offen sc1
    buffer_load_dwordx4 a[44:47], v2, s[60:63], s17 offen sc1
    s_add_u32 s17, s17, 1024
    s_cmp_eq_u32 s17, s100
    s_cselect_b32 s17, s33, s17
    ds_read_b32 v3, v7 offset:16
    s_waitcnt vmcnt(8)
    v_mfma_f32_32x32x16_bf16 v[64:79], a[24:27], a[88:91], v[64:79]
    v_mfma_f32_32x32x16_bf16 v[80:95], a[24:27], a[92:95], v[80:95]
    v_mfma_f32_32x32x16_bf16 v[96:111], a[28:31], a[88:91], v[96:111]
    v_mfma_f32_32x32x16_bf16 v[112:127], a[28:31], a[92:95], v[112:127]
    buffer_load_dwordx4 v[48:51], v1, s[60:63], s17 offen sc1
    buffer_load_dwordx4 v[52:55], v2, s[60:63], s17 offen sc1
    s_add_u32 s17, s17, 1024
    s_cmp_eq_u32 s17, s100
    s_cselect_b32 s17, s33, s17
    s_waitcnt vmcnt(8)
    v_mfma_f32_32x32x16_bf16 v[64:79], v[40:43], a[96:99], v[64:79]
    v_mfma_f32_32x32x16_bf16 v[80:95], v[40:43], a[100:103], v[80:95]
    v_mfma_f32_32x32x16_bf16 v[96:111], v[44:47], a[96:99], v[96:111]
    v_mfma_f32_32x32x16_bf16 v[112:127], v[44:47], a[100:103], v[112:127]
    buffer_load_dwordx4 a[48:51], v1, s[60:63], s17 offen sc1
    buffer_load_dwordx4 a[52:55], v2, s[60:63], s17 offen sc1
    s_add_u32 s17, s17, 1024
    s_cmp_eq_u32 s17, s100
    s_cselect_b32 s17, s33, s17
    s_waitcnt vmcnt(8)
    v_mfma_f32_32x32x16_bf16 v[64:79], a[32:35], a[104:107], v[64:79]
    v_mfma_f32_32x32x16_bf16 v[80:95], a[32:35], a[108:111], v[80:95]
    v_mfma_f32_32x32x16_bf16 v[96:111], a[36:39], a[104:107], v[96:111]
    v_mfma_f32_32x32x16_bf16 v[112:127], a[36:39], a[108:111], v[112:127]
    buffer_load_dwordx4 a[8:11], v1, s[60:63], s17 offen sc1
    buffer_load_dwordx4 a[12:15], v2, s[60:63], s17 offen sc1
    s_waitcnt vmcnt(8)
    v_mfma_f32_32x32x16_bf16 v[64:79], a[0:3], a[112:115], v[64:79]
    v_mfma_f32_32x32x16_bf16 v[80:95], a[0:3], a[116:119], v[80:95]
    v_mfma_f32_32x32x16_bf16 v[96:111], a[4:7], a[112:115], v[96:111]
    v_mfma_f32_32x32x16_bf16 v[112:127], a[4:7], a[116:119], v[112:127]
    s_waitcnt vmcnt(6)
    v_mfma_f32_32x32x16_bf16 v[64:79], a[40:43], a[120:123], v[64:79]
    v_mfma_f32_32x32x16_bf16 v[80:95], a[40:43], a[124:127], v[80:95]
    v_mfma_f32_32x32x16_bf16 v[96:111], a[44:47], a[120:123], v[96:111]
    v_mfma_f32_32x32x16_bf16 v[112:127], a[44:47], a[124:127], v[112:127]
    s_waitcnt vmcnt(4)
    v_mfma_f32_32x32x16_bf16 v[64:79], v[48:51], v[16:19], v[64:79]
    v_mfma_f32_32x32x16_bf16 v[80:95], v[48:51], v[20:23], v[80:95]
    v_mfma_f32_32x32x16_bf16 v[96:111], v[52:55], v[16:19], v[96:111]
    v_mfma_f32_32x32x16_bf16 v[112:127], v[52:55], v[20:23], v[112:127]
    s_waitcnt vmcnt(2)
    v_mfma_f32_32x32x16_bf16 v[64:79], a[48:51], v[24:27], v[64:79]
    v_mfma_f32_32x32x16_bf16 v[80:95], a[48:51], v[28:31], v[80:95]
    v_mfma_f32_32x32x16_bf16 v[96:111], a[52:55], v[24:27], v[96:111]
    v_mfma_f32_32x32x16_bf16 v[112:127], a[52:55], v[28:31], v[112:127]
    s_waitcnt vmcnt(0)
    v_mfma_f32_32x32x16_bf16 v[64:79], a[8:11], v[32:35], v[64:79]
    v_mfma_f32_32x32x16_bf16 v[80:95], a[8:11], v[36:39], v[80:95]
    v_mfma_f32_32x32x16_bf16 v[96:111], a[12:15], v[32:35], v[96:111]
    v_mfma_f32_32x32x16_bf16 v[112:127], a[12:15], v[36:39], v[112:127]
    s_waitcnt lgkmcnt(0)
    v_readfirstlane_b32 s15, v3
    s_nop 0
    s_cmp_lt_u32 s15, 4
    s_cbranch_scc1 CS_24
CB_25:
    v_add_u32 v2, s27, v0
    v_add_u32 v3, s26, v0
    s_nop 2
    ds_write_b128 v3, v[80:83] offset:0
    ds_write_b128 v3, v[84:87] offset:1024
    ds_write_b128 v3, v[88:91] offset:2048
    ds_write_b128 v3, v[92:95] offset:3072
    ds_write_b128 v3, v[96:99] offset:4096
    ds_write_b128 v3, v[100:103] offset:5120
    ds_write_b128 v3, v[104:107] offset:6144
    ds_write_b128 v3, v[108:111] offset:7168
    ds_write_b128 v3, v[112:115] offset:8192
    ds_write_b128 v3, v[116:119] offset:9216
    ds_write_b128 v3, v[120:123] offset:10240
    ds_write_b128 v3, v[124:127] offset:11264
    s_xor_b32 s12, s3, 1
    s_mul_i32 s13, s12, 12288
    v_add_u32 v9, s13, v0
    s_lshl_b32 s12, s12, 13
    s_add_u32 s12, s12, 65536
    v_add_u32 v13, s12, v0
    s_xor_b32 s12, s3, 2
    s_mul_i32 s13, s12, 12288
    v_add_u32 v10, s13, v0
    s_lshl_b32 s12, s12, 13
    s_add_u32 s12, s12, 69632
    v_add_u32 v14, s12, v0
    s_xor_b32 s12, s3, 3
    s_mul_i32 s13, s12, 12288
    v_add_u32 v11, s13, v0
    s_lshl_b32 s12, s12, 12
    s_add_u32 s12, s12, 49152
    v_add_u32 v15, s12, v0
    v_bfe_u32 v1, v0, 4, 5
    v_lshlrev_b32 v1, 2, v1
    v_lshrrev_b32 v3, 9, v0
    v_lshl_add_u32 v1, v3, 15, v1
    v_mov_b32 v5, 1
    s_waitcnt lgkmcnt(0)
    s_mov_b64 exec, 1
    ds_add_u32 v7, v5 offset:32
    s_mov_b64 exec, -1
    s_waitcnt lgkmcnt(0)
    s_mov_b32 s24, 0
SP_27:
    ds_read_b32 v4, v7 offset:32
    s_add_u32 s24, s24, 1
    s_waitcnt lgkmcnt(0)
    v_readfirstlane_b32 s15, v4
    s_cmp_gt_u32 s24, 200000
    s_cbranch_scc1 SD_28
    s_cmp_lt_u32 s15, 4
    s_cbranch_scc1 SP_27
SD_28:
    ds_read_b128 v[80:83], v9 offset:0
    ds_read_b128 v[84:87], v9 offset:1024
    ds_read_b128 v[88:91], v9 offset:2048
    ds_read_b128 v[92:95], v9 offset:3072
    ds_read_b128 v[96:99], v10 offset:4096
    ds_read_b128 v[100:103], v10 offset:5120
    ds_read_b128 v[104:107], v10 offset:6144
    ds_read_b128 v[108:111], v10 offset:7168
    ds_read_b128 v[112:115], v11 offset:8192
    ds_read_b128 v[116:119], v11 offset:9216
    ds_read_b128 v[120:123], v11 offset:10240
    ds_read_b128 v[124:127], v11 offset:11264
    s_waitcnt lgkmcnt(8)
    v_pk_add_f32 v[64:65], v[64:65], v[80:81]
    v_pk_add_f32 v[66:67], v[66:67], v[82:83]
    v_pk_add_f32 v[68:69], v[68:69], v[84:85]
    v_pk_add_f32 v[70:71], v[70:71], v[86:87]
    v_pk_add_f32 v[72:73], v[72:73], v[88:89]
    v_pk_add_f32 v[74:75], v[74:75], v[90:91]
    v_pk_add_f32 v[76:77], v[76:77], v[92:93]
    v_pk_add_f32 v[78:79], v[78:79], v[94:95]
    s_waitcnt lgkmcnt(4)
    v_pk_add_f32 v[64:65], v[64:65], v[96:97]
    v_pk_add_f32 v[66:67], v[66:67], v[98:99]
    v_pk_add_f32 v[68:69], v[68:69], v[100:101]
    v_pk_add_f32 v[70:71], v[70:71], v[102:103]
    v_pk_add_f32 v[72:73], v[72:73], v[104:105]
    v_pk_add_f32 v[74:75], v[74:75], v[106:107]
    v_pk_add_f32 v[76:77], v[76:77], v[108:109]
    v_pk_add_f32 v[78:79], v[78:79], v[110:111]
    s_waitcnt lgkmcnt(0)
    v_pk_add_f32 v[64:65], v[64:65], v[112:113]
    v_pk_add_f32 v[66:67], v[66:67], v[114:115]
    v_pk_add_f32 v[68:69], v[68:69], v[116:117]
    v_pk_add_f32 v[70:71], v[70:71], v[118:119]
    v_pk_add_f32 v[72:73], v[72:73], v[120:121]
    v_pk_add_f32 v[74:75], v[74:75], v[122:123]
    v_pk_add_f32 v[76:77], v[76:77], v[124:125]
    v_pk_add_f32 v[78:79], v[78:79], v[126:127]
    ds_write_b128 v2, v[72:75] offset:0
    ds_write_b128 v2, v[76:79] offset:1024
    s_waitcnt lgkmcnt(0)
    s_barrier
    ds_read_b128 v[72:75], v2 offset:8192
    ds_read_b128 v[76:79], v2 offset:9216
    ds_read_b128 v[80:83], v13 offset:0
    ds_read_b128 v[84:87], v13 offset:1024
    ds_read_b128 v[88:91], v14 offset:0
    ds_read_b128 v[92:95], v14 offset:1024
    ds_read_b128 v[96:99], v15 offset:0
    ds_read_b128 v[100:103], v15 offset:1024
    s_waitcnt lgkmcnt(6)
    v_pk_add_f32 v[64:65], v[64:65], v[72:73]
    v_pk_add_f32 v[66:67], v[66:67], v[74:75]
    v_pk_add_f32 v[68:69], v[68:69], v[76:77]
    v_pk_add_f32 v[70:71], v[70:71], v[78:79]
    s_waitcnt lgkmcnt(4)
    v_pk_add_f32 v[64:65], v[64:65], v[80:81]
    v_pk_add_f32 v[66:67], v[66:67], v[82:83]
    v_pk_add_f32 v[68:69], v[68:69], v[84:85]
    v_pk_add_f32 v[70:71], v[70:71], v[86:87]
    s_waitcnt lgkmcnt(2)
    v_pk_add_f32 v[64:65], v[64:65], v[88:89]
    v_pk_add_f32 v[66:67], v[66:67], v[90:91]
    v_pk_add_f32 v[68:69], v[68:69], v[92:93]
    v_pk_add_f32 v[70:71], v[70:71], v[94:95]
    s_waitcnt lgkmcnt(0)
    v_pk_add_f32 v[64:65], v[64:65], v[96:97]
    v_pk_add_f32 v[66:67], v[66:67], v[98:99]
    v_pk_add_f32 v[68:69], v[68:69], v[100:101]
    v_pk_add_f32 v[70:71], v[70:71], v[102:103]
    buffer_store_dword v64, v1, s[68:71], s16 offen offset:0 nt
    buffer_store_dword v65, v1, s[68:71], s16 offen offset:2048 nt
    s_add_u32 s16, s16, 4096
    buffer_store_dword v66, v1, s[68:71], s16 offen offset:0 nt
    buffer_store_dword v67, v1, s[68:71], s16 offen offset:2048 nt
    s_add_u32 s16, s16, 4096
    buffer_store_dword v68, v1, s[68:71], s16 offen offset:0 nt
    buffer_store_dword v69, v1, s[68:71], s16 offen offset:2048 nt
    s_add_u32 s16, s16, 4096
    buffer_store_dword v70, v1, s[68:71], s16 offen offset:0 nt
    buffer_store_dword v71, v1, s[68:71], s16 offen offset:2048 nt
    s_endpgm
CS_1:
    s_mov_b32 s24, 0
CL_3:
    ds_read_b32 v52, v7 offset:8
    s_add_u32 s24, s24, 1
    s_waitcnt lgkmcnt(0)
    v_readfirstlane_b32 s15, v52
    s_cmp_gt_u32 s24, 200000
    s_cbranch_scc1 CB_2
    s_cmp_lt_u32 s15, 4
    s_cbranch_scc1 CL_3
    s_branch CB_2
CS_4:
    s_mov_b32 s24, 0
CL_6:
    ds_read_b32 v52, v7 offset:8
    s_add_u32 s24, s24, 1
    s_waitcnt lgkmcnt(0)
    v_readfirstlane_b32 s15, v52
    s_cmp_gt_u32 s24, 200000
    s_cbranch_scc1 CB_5
    s_cmp_lt_u32 s15, 8
    s_cbranch_scc1 CL_6
    s_branch CB_5
CS_7:
    s_mov_b32 s24, 0
CL_9:
    ds_read_b32 v52, v7 offset:8
    s_add_u32 s24, s24, 1
    s_waitcnt lgkmcnt(0)
    v_readfirstlane_b32 s15, v52
    s_cmp_gt_u32 s24, 200000
    s_cbranch_scc1 CB_8
    s_cmp_lt_u32 s15, 12
    s_cbranch_scc1 CL_9
    s_branch CB_8
CS_10:
    s_mov_b32 s24, 0
CL_12:
    ds_read_b32 v52, v7 offset:8
    s_add_u32 s24, s24, 1
    s_waitcnt lgkmcnt(0)
    v_readfirstlane_b32 s15, v52
    s_cmp_gt_u32 s24, 200000
    s_cbranch_scc1 CB_11
    s_cmp_lt_u32 s15, 16
    s_cbranch_scc1 CL_12
    s_branch CB_11
CS_13:
    s_mov_b32 s24, 0
CL_15:
    ds_read_b32 v52, v7 offset:8
    s_add_u32 s24, s24, 1
    s_waitcnt lgkmcnt(0)
    v_readfirstlane_b32 s15, v52
    s_cmp_gt_u32 s24, 200000
    s_cbranch_scc1 CB_14
    s_cmp_lt_u32 s15, 20
    s_cbranch_scc1 CL_15
    s_branch CB_14
CS_16:
    s_mov_b32 s24, 0
CL_18:
    ds_read_b32 v52, v7 offset:12
    s_add_u32 s24, s24, 1
    s_waitcnt lgkmcnt(0)
    v_readfirstlane_b32 s15, v52
    s_cmp_gt_u32 s24, 200000
    s_cbranch_scc1 CB_17
    s_cmp_lt_u32 s15, 4
    s_cbranch_scc1 CL_18
    s_branch CB_17
PL_21:
    s_mov_b32 s24, 0
PC_23:
    s_buffer_load_dwordx8 s[92:99], s[60:63], s32 glc
    s_buffer_load_dwordx2 s[46:47], s[60:63], s32 offset:32 glc
    s_add_u32 s24, s24, 1
    s_cmp_gt_u32 s24, 200000
    s_cbranch_scc1 PC_23x
    s_waitcnt lgkmcnt(0)
    s_cmp_eq_u32 s3, 3
    s_cselect_b64 s[46:47], s[46:47], s[36:37]
    s_xor_b64 s[92:93], s[92:93], s[36:37]
    s_xor_b64 s[94:95], s[94:95], s[36:37]
    s_xor_b64 s[96:97], s[96:97], s[36:37]
    s_xor_b64 s[98:99], s[98:99], s[36:37]
    s_xor_b64 s[46:47], s[46:47], s[36:37]
    s_or_b64 s[92:93], s[92:93], s[94:95]
    s_or_b64 s[92:93], s[92:93], s[96:97]
    s_or_b64 s[92:93], s[92:93], s[98:99]
    s_or_b64 s[92:93], s[92:93], s[46:47]
    s_cbranch_scc1 PC_23
PC_23x:
    s_waitcnt lgkmcnt(0)
    s_branch PD_22
CS_24:
    s_mov_b32 s24, 0
CL_26:
    ds_read_b32 v3, v7 offset:16
    s_add_u32 s24, s24, 1
    s_waitcnt lgkmcnt(0)
    v_readfirstlane_b32 s15, v3
    s_cmp_gt_u32 s24, 200000
    s_cbranch_scc1 CB_25
    s_cmp_lt_u32 s15, 4
    s_cbranch_scc1 CL_26
    s_branch CB_25
S_START:
    s_load_dwordx2 s[64:65], s[0:1], 96
    s_load_dwordx4 s[72:75], s[0:1], 8
    s_load_dwordx2 s[76:77], s[0:1], 56
    s_mov_b32 s66, 4194304
    s_mov_b32 s67, 0x20000
    s_lshl_b32 s29, s3, 12
    s_add_u32 s29, s29, 49152
    s_lshr_b32 s12, s4, 1
    s_mul_i32 s12, s12, 1
    s_mul_i32 s13, s6, 0
    s_add_u32 s10, s12, s13
    s_lshl_b32 s18, s6, 16
    s_lshl_b32 s12, s3, 8
    s_add_u32 s18, s18, s12
    s_and_b32 s12, s3, 1
    s_lshl_b32 s12, s12, 15
    s_add_u32 s18, s18, s12
    s_xor_b32 s23, s18, 32768
    v_and_b32 v2, 31, v0
    s_lshl_b32 s12, s5, 5
    v_add_u32 v2, s12, v2
    v_lshlrev_b32 v2, 1, v2
    v_lshlrev_b32 v3, 2, v0
    v_add_u32 v3, 148992, v3
    v_mov_b32 v16, 0
    s_cmp_eq_u32 s3, 0
    s_cbranch_scc0 S_NOZ
    ds_write_b32 v3, v16
S_NOZ:
    s_waitcnt lgkmcnt(0)
    global_load_ushort v92, v2, s[72:73]
    global_load_ushort v93, v2, s[74:75]
    global_load_ushort v94, v2, s[76:77]
    s_load_dwordx4 s[72:75], s[0:1], 40
    v_and_b32 v2, 31, v0
    v_lshrrev_b32 v3, 1, v2
    v_and_b32 v3, 7, v3
    v_lshrrev_b32 v4, 5, v0
    v_xor_b32 v3, v3, v4
    s_lshl_b32 s13, s3, 1
    v_xor_b32 v3, s13, v3
    v_lshlrev_b32 v3, 4, v3
    v_lshl_add_u32 v2, v2, 7, v3
    v_add_u32 v12, 65536, v2
    v_xor_b32 v13, 32, v12
    v_xor_b32 v14, 64, v12
    v_xor_b32 v15, 96, v12
    v_bfe_u32 v76, v0, 4, 1
    v_lshlrev_b32 v76, 2, v76
    v_and_b32 v77, 15, v0
    v_mov_b32 v78, 0x3f803f80
    v_add_u32 v79, 8, v76
    v_cmp_eq_u32 vcc, v79, v77
    s_nop 1
    v_cndmask_b32 v80, 0, v78, vcc
    v_cmp_eq_u32 vcc, v76, v77
    s_nop 1
    v_cndmask_b32 v76, 0, v78, vcc
    v_mov_b32 v77, v76
    v_mov_b32 v81, v80
    v_mov_b32 v78, v76
    v_mov_b32 v82, v80
    v_mov_b32 v79, v76
    v_mov_b32 v83, v80
    s_lshl_b32 s12, s3, 8
    s_add_u32 s12, s12, 149504
    v_lshl_add_u32 v32, v0, 2, s12
    v_lshrrev_b32 v95, 5, v0
    v_and_b32 v99, 31, v0
    v_mov_b32 v6, 148992
    s_lshl_b32 s12, s3, 7
    s_add_u32 s12, s12, 147456
    v_lshlrev_b32 v33, 6, v95
    v_add_u32 v33, s12, v33
    v_lshlrev_b32 v34, 4, v99
    v_add_u32 v34, 155648, v34
    s_lshl_b32 s12, s3, 9
    s_add_u32 s12, s12, 152576
    v_lshlrev_b32 v35, 3, v0
    v_add_u32 v35, s12, v35
    v_lshlrev_b32 v0, 4, v0
    s_lshl_b32 s12, s3, 2
    s_add_u32 s12, s12, 155648
    v_add_u32 v36, s12, v0
    s_waitcnt vmcnt(6)
    s_barrier
    ds_read_b128 v[16:19], v8 offset:0
    ds_read_b128 a[0:3], v12 offset:0
    ds_read_b128 a[4:7], v12 offset:4096
    ds_read_b128 v[20:23], v9 offset:0
    ds_read_b128 a[8:11], v13 offset:0
    ds_read_b128 a[12:15], v13 offset:4096
    s_waitcnt lgkmcnt(3)
    v_mfma_f32_32x32x16_bf16 v[40:55], v[16:19], a[0:3], 0
    ds_read_b128 v[24:27], v10 offset:0
    v_mfma_f32_16x16x32_bf16 v[72:75], v[76:79], a[0:3], 0
    ds_read_b128 a[16:19], v14 offset:0
    v_mfma_f32_32x32x16_bf16 v[56:71], v[16:19], a[4:7], 0
    ds_read_b128 a[20:23], v14 offset:4096
    v_mfma_f32_16x16x32_bf16 v[72:75], v[80:83], a[4:7], v[72:75]
    s_waitcnt lgkmcnt(3)
    v_mfma_f32_32x32x16_bf16 v[40:55], v[20:23], a[8:11], v[40:55]
    ds_read_b128 v[28:31], v11 offset:0
    ds_read_b128 a[24:27], v15 offset:0
    v_mfma_f32_32x32x16_bf16 v[56:71], v[20:23], a[12:15], v[56:71]
    ds_read_b128 a[28:31], v15 offset:4096
    s_waitcnt vmcnt(3) lgkmcnt(0)
    s_barrier
    v_mfma_f32_32x32x16_bf16 v[40:55], v[24:27], a[16:19], v[40:55]
    ds_read_b128 v[16:19], v8 offset:16384
    ds_read_b128 a[0:3], v12 offset:8192
    v_mfma_f32_32x32x16_bf16 v[56:71], v[24:27], a[20:23], v[56:71]
    ds_read_b128 a[4:7], v12 offset:12288
    v_mfma_f32_32x32x16_bf16 v[40:55], v[28:31], a[24:27], v[40:55]
    ds_read_b128 v[20:23], v9 offset:16384
    ds_read_b128 a[8:11], v13 offset:8192
    v_mfma_f32_32x32x16_bf16 v[56:71], v[28:31], a[28:31], v[56:71]
    ds_read_b128 a[12:15], v13 offset:12288
    s_waitcnt lgkmcnt(3)
    v_mfma_f32_32x32x16_bf16 v[40:55], v[16:19], a[0:3], v[40:55]
    ds_read_b128 v[24:27], v10 offset:16384
    v_mfma_f32_16x16x32_bf16 v[72:75], v[76:79], a[0:3], v[72:75]
    ds_read_b128 a[16:19], v14 offset:8192
    v_mfma_f32_32x32x16_bf16 v[56:71], v[16:19], a[4:7], v[56:71]
    ds_read_b128 a[20:23], v14 offset:12288
    v_mfma_f32_16x16x32_bf16 v[72:75], v[80:83], a[4:7], v[72:75]
    s_waitcnt lgkmcnt(3)
    v_mfma_f32_32x32x16_bf16 v[40:55], v[20:23], a[8:11], v[40:55]
    ds_read_b128 v[28:31], v11 offset:16384
    ds_read_b128 a[24:27], v15 offset:8192
    v_mfma_f32_32x32x16_bf16 v[56:71], v[20:23], a[12:15], v[56:71]
    ds_read_b128 a[28:31], v15 offset:12288
    s_waitcnt lgkmcnt(0)
    s_barrier
    v_mfma_f32_32x32x16_bf16 v[40:55], v[24:27], a[16:19], v[40:55]
    ds_read_b128 v[16:19], v8 offset:32768
    ds_read_b128 a[0:3], v12 offset:16384
    v_mfma_f32_32x32x16_bf16 v[56:71], v[24:27], a[20:23], v[56:71]
    ds_read_b128 a[4:7], v12 offset:20480
    v_mfma_f32_32x32x16_bf16 v[40:55], v[28:31], a[24:27], v[40:55]
    ds_read_b128 v[20:23], v9 offset:32768
    ds_read_b128 a[8:11], v13 offset:16384
    v_mfma_f32_32x32x16_bf16 v[56:71], v[28:31], a[28:31], v[56:71]
    ds_read_b128 a[12:15], v13 offset:20480
    s_waitcnt lgkmcnt(3)
    v_mfma_f32_32x32x16_bf16 v[40:55], v[16:19], a[0:3], v[40:55]
    ds_read_b128 v[24:27], v10 offset:32768
    v_mfma_f32_16x16x32_bf16 v[72:75], v[76:79], a[0:3], v[72:75]
    ds_read_b128 a[16:19], v14 offset:16384
    v_mfma_f32_32x32x16_bf16 v[56:71], v[16:19], a[4:7], v[56:71]
    ds_read_b128 a[20:23], v14 offset:20480
    v_mfma_f32_16x16x32_bf16 v[72:75], v[80:83], a[4:7], v[72:75]
    s_waitcnt lgkmcnt(3)
    v_mfma_f32_32x32x16_bf16 v[40:55], v[20:23], a[8:11], v[40:55]
    ds_read_b128 v[28:31], v11 offset:32768
    ds_read_b128 a[24:27], v15 offset:16384
    v_mfma_f32_32x32x16_bf16 v[56:71], v[20:23], a[12:15], v[56:71]
    ds_read_b128 a[28:31], v15 offset:20480
    s_waitcnt lgkmcnt(0)
    s_barrier
    v_mfma_f32_32x32x16_bf16 v[40:55], v[24:27], a[16:19], v[40:55]
    ds_read_b128 v[16:19], v8 offset:49152
    ds_read_b128 a[0:3], v12 offset:24576
    v_mfma_f32_32x32x16_bf16 v[56:71], v[24:27], a[20:23], v[56:71]
    ds_read_b128 a[4:7], v12 offset:28672
    v_mfma_f32_32x32x16_bf16 v[40:55], v[28:31], a[24:27], v[40:55]
    ds_read_b128 v[20:23], v9 offset:49152
    ds_read_b128 a[8:11], v13 offset:24576
    v_mfma_f32_32x32x16_bf16 v[56:71], v[28:31], a[28:31], v[56:71]
    ds_read_b128 a[12:15], v13 offset:28672
    s_waitcnt lgkmcnt(3)
    v_mfma_f32_32x32x16_bf16 v[40:55], v[16:19], a[0:3], v[40:55]
    ds_read_b128 v[24:27], v10 offset:49152
    v_mfma_f32_16x16x32_bf16 v[72:75], v[76:79], a[0:3], v[72:75]
    ds_read_b128 a[16:19], v14 offset:24576
    v_mfma_f32_32x32x16_bf16 v[56:71], v[16:19], a[4:7], v[56:71]
    ds_read_b128 a[20:23], v14 offset:28672
    v_mfma_f32_16x16x32_bf16 v[72:75], v[80:83], a[4:7], v[72:75]
    s_waitcnt lgkmcnt(3)
    v_mfma_f32_32x32x16_bf16 v[40:55], v[20:23], a[8:11], v[40:55]
    ds_read_b128 v[28:31], v11 offset:49152
    ds_read_b128 a[24:27], v15 offset:24576
    v_mfma_f32_32x32x16_bf16 v[56:71], v[20:23], a[12:15], v[56:71]
    ds_read_b128 a[28:31], v15 offset:28672
    s_waitcnt lgkmcnt(0)
    s_barrier
    v_mfma_f32_32x32x16_bf16 v[40:55], v[24:27], a[16:19], v[40:55]
    ds_read_b128 v[16:19], v8 offset:0
    ds_read_b128 a[0:3], v12 offset:0
    v_mfma_f32_32x32x16_bf16 v[56:71], v[24:27], a[20:23], v[56:71]
    ds_read_b128 a[4:7], v12 offset:4096
    v_mfma_f32_32x32x16_bf16 v[40:55], v[28:31], a[24:27], v[40:55]
    ds_read_b128 v[20:23], v9 offset:0
    ds_read_b128 a[8:11], v13 offset:0
    v_mfma_f32_32x32x16_bf16 v[56:71], v[28:31], a[28:31], v[56:71]
    ds_read_b128 a[12:15], v13 offset:4096
    s_waitcnt lgkmcnt(3)
    v_mfma_f32_32x32x16_bf16 v[40:55], v[16:19], a[0:3], v[40:55]
    ds_read_b128 v[24:27], v10 offset:0
    ds_read_b128 a[16:19], v14 offset:0
    v_mfma_f32_16x16x32_bf16 v[72:75], v[76:79], a[0:3], v[72:75]
    ds_read_b128 a[20:23], v14 offset:4096
    s_waitcnt vmcnt(0)
    v_mfma_f32_32x32x16_bf16 v[56:71], v[16:19], a[4:7], v[56:71]
    v_lshlrev_b32 v92, 16, v92
    v_lshlrev_b32 v93, 16, v93
    v_mfma_f32_16x16x32_bf16 v[72:75], v[80:83], a[4:7], v[72:75]
    v_lshlrev_b32 v94, 16, v94
    v_mul_f32 v94, 0x3fb8aa3b, v94
    s_waitcnt lgkmcnt(3)
    v_mfma_f32_32x32x16_bf16 v[40:55], v[20:23], a[8:11], v[40:55]
    ds_read_b128 v[28:31], v11 offset:0
    ds_read_b128 a[24:27], v15 offset:0
    ds_read_b128 a[28:31], v15 offset:4096
    v_exp_f32 v94, v94
    v_mfma_f32_32x32x16_bf16 v[56:71], v[20:23], a[12:15], v[56:71]
    v_cvt_pk_bf16_f32 v94, v94, v94
    v_lshlrev_b32 v94, 16, v94
    v_mul_f32 v88, v94, v92
    s_waitcnt lgkmcnt(0)
    s_barrier
    v_mfma_f32_32x32x16_bf16 v[40:55], v[24:27], a[16:19], v[40:55]
    ds_read_b128 v[16:19], v8 offset:16384
    ds_read_b128 a[0:3], v12 offset:8192
    ds_read_b128 a[4:7], v12 offset:12288
    v_mov_b32 v2, 0
    buffer_load_dword v3, v2, s[68:71], 0 offen sc1
    v_mfma_f32_32x32x16_bf16 v[56:71], v[24:27], a[20:23], v[56:71]
    v_mul_f32 v89, v94, v93
    v_mul_f32 v88, 0x3fb8aa3b, v88
    v_exp_f32 v88, v88
    v_mul_f32 v89, 0.15915494, v89
    v_mfma_f32_32x32x16_bf16 v[40:55], v[28:31], a[24:27], v[40:55]
    ds_read_b128 v[20:23], v9 offset:16384
    ds_read_b128 a[8:11], v13 offset:8192
    ds_read_b128 a[12:15], v13 offset:12288
    v_fract_f32 v89, v89
    v_mfma_f32_32x32x16_bf16 v[56:71], v[28:31], a[28:31], v[56:71]
    v_sin_f32 v90, v89
    v_cos_f32 v91, v89
    s_nop 0
    v_mul_f32 v96, v88, v91
    s_waitcnt lgkmcnt(3)
    v_mfma_f32_32x32x16_bf16 v[40:55], v[16:19], a[0:3], v[40:55]
    ds_read_b128 v[24:27], v10 offset:16384
    ds_read_b128 a[16:19], v14 offset:8192
    v_mfma_f32_16x16x32_bf16 v[72:75], v[76:79], a[0:3], v[72:75]
    ds_read_b128 a[20:23], v14 offset:12288
    v_mul_f32 v97, v88, v90
    v_mfma_f32_32x32x16_bf16 v[56:71], v[16:19], a[4:7], v[56:71]
    v_sub_f32 v98, 0, v97
    v_mul_f32 v88, v92, v92
    v_mfma_f32_16x16x32_bf16 v[72:75], v[80:83], a[4:7], v[72:75]
    v_fmac_f32 v88, v93, v93
    s_waitcnt lgkmcnt(3)
    v_mfma_f32_32x32x16_bf16 v[40:55], v[20:23], a[8:11], v[40:55]
    ds_read_b128 v[28:31], v11 offset:16384
    ds_read_b128 a[24:27], v15 offset:8192
    ds_read_b128 a[28:31], v15 offset:12288
    v_rcp_f32 v88, v88
    v_mfma_f32_32x32x16_bf16 v[56:71], v[20:23], a[12:15], v[56:71]
    v_add_f32 v89, -1.0, v96
    v_add_f32 v88, v88, v88
    v_mul_f32 v100, v89, v92
    s_waitcnt lgkmcnt(0)
    s_barrier
    v_mfma_f32_32x32x16_bf16 v[40:55], v[24:27], a[16:19], v[40:55]
    ds_read_b128 v[16:19], v8 offset:32768
    ds_read_b128 a[0:3], v12 offset:16384
    ds_read_b128 a[4:7], v12 offset:20480
    v_fmac_f32 v100, v97, v93
    v_mfma_f32_32x32x16_bf16 v[56:71], v[24:27], a[20:23], v[56:71]
    v_mul_f32 v101, v97, v92
    v_fma_f32 v101, -v89, v93, v101
    v_mul_f32 v100, v100, v88
    v_mfma_f32_32x32x16_bf16 v[40:55], v[28:31], a[24:27], v[40:55]
    ds_read_b128 v[20:23], v9 offset:32768
    ds_read_b128 a[8:11], v13 offset:16384
    ds_read_b128 a[12:15], v13 offset:20480
    v_mul_f32 v101, v101, v88
    v_mfma_f32_32x32x16_bf16 v[56:71], v[28:31], a[28:31], v[56:71]
    v_mul_f32 v88, v96, v96
    v_add_f32 v89, v96, v96
    v_fma_f32 v88, -v97, v97, v88
    s_waitcnt lgkmcnt(3)
    v_mfma_f32_32x32x16_bf16 v[40:55], v[16:19], a[0:3], v[40:55]
    ds_read_b128 v[24:27], v10 offset:32768
    ds_read_b128 a[16:19], v14 offset:16384
    v_mfma_f32_16x16x32_bf16 v[72:75], v[76:79], a[0:3], v[72:75]
    ds_read_b128 a[20:23], v14 offset:20480
    v_mul_f32 v89, v89, v97
    v_mfma_f32_32x32x16_bf16 v[56:71], v[16:19], a[4:7], v[56:71]
    v_mul_f32 v90, v88, v88
    v_add_f32 v91, v88, v88
    v_mfma_f32_16x16x32_bf16 v[72:75], v[80:83], a[4:7], v[72:75]
    v_fma_f32 v90, -v89, v89, v90
    s_waitcnt lgkmcnt(3)
    v_mfma_f32_32x32x16_bf16 v[40:55], v[20:23], a[8:11], v[40:55]
    ds_read_b128 v[28:31], v11 offset:32768
    ds_read_b128 a[24:27], v15 offset:16384
    ds_read_b128 a[28:31], v15 offset:20480
    v_mul_f32 v91, v91, v89
    v_mfma_f32_32x32x16_bf16 v[56:71], v[20:23], a[12:15], v[56:71]
    v_mul_f32 v88, v90, v90
    v_add_f32 v89, v90, v90
    v_fma_f32 v88, -v91, v91, v88
    s_waitcnt lgkmcnt(0)
    s_barrier
    v_mfma_f32_32x32x16_bf16 v[40:55], v[24:27], a[16:19], v[40:55]
    ds_read_b128 v[16:19], v8 offset:49152
    ds_read_b128 a[0:3], v12 offset:24576
    ds_read_b128 a[4:7], v12 offset:28672
    v_mul_f32 v89, v89, v91
    v_mfma_f32_32x32x16_bf16 v[56:71], v[24:27], a[20:23], v[56:71]
    v_mul_f32 v102, v88, v88
    v_add_f32 v103, v88, v88
    v_fma_f32 v102, -v89, v89, v102
    v_mfma_f32_32x32x16_bf16 v[40:55], v[28:31], a[24:27], v[40:55]
    ds_read_b128 v[20:23], v9 offset:49152
    ds_read_b128 a[8:11], v13 offset:24576
    ds_read_b128 a[12:15], v13 offset:28672
    v_mfma_f32_32x32x16_bf16 v[56:71], v[28:31], a[28:31], v[56:71]
    v_mul_f32 v103, v103, v89
    v_mov_b32 v94, v99
    v_mov_b32 v92, 1
    s_waitcnt lgkmcnt(3)
    v_mfma_f32_32x32x16_bf16 v[40:55], v[16:19], a[0:3], v[40:55]
    ds_read_b128 v[24:27], v10 offset:49152
    v_mfma_f32_16x16x32_bf16 v[72:75], v[76:79], a[0:3], v[72:75]
    ds_read_b128 a[16:19], v14 offset:24576
    v_mfma_f32_32x32x16_bf16 v[56:71], v[16:19], a[4:7], v[56:71]
    ds_read_b128 a[20:23], v14 offset:28672
    v_mfma_f32_16x16x32_bf16 v[72:75], v[80:83], a[4:7], v[72:75]
    s_waitcnt lgkmcnt(3)
    v_mfma_f32_32x32x16_bf16 v[40:55], v[20:23], a[8:11], v[40:55]
    ds_read_b128 v[28:31], v11 offset:49152
    ds_read_b128 a[24:27], v15 offset:24576
    v_mfma_f32_32x32x16_bf16 v[56:71], v[20:23], a[12:15], v[56:71]
    ds_read_b128 a[28:31], v15 offset:28672
    s_waitcnt lgkmcnt(3)
    v_mfma_f32_32x32x16_bf16 v[40:55], v[24:27], a[16:19], v[40:55]
    v_cvt_pk_bf16_f32 v73, v72, v72
    v_lshlrev_b32 v73, 16, v73
    v_sub_f32 v73, v72, v73
    v_cvt_pk_bf16_f32 v72, v72, v73
    ds_write_b32 v36, v72
    v_mfma_f32_32x32x16_bf16 v[56:71], v[24:27], a[20:23], v[56:71]
    s_waitcnt vmcnt(0)
    s_mov_b32 s24, 0
S_NL:
    v_readfirstlane_b32 s22, v3
    s_add_u32 s24, s24, 1
    s_cmp_lg_u32 s22, 0
    s_cbranch_scc1 S_NOK
    s_cmp_gt_u32 s24, 200000
    s_cbranch_scc1 S_NOK
    buffer_load_dword v3, v2, s[68:71], 0 offen sc1
    s_waitcnt vmcnt(0)
    s_branch S_NL
S_NOK:
    ds_write_b32 v6, v3 offset:60
    s_waitcnt lgkmcnt(2)
    v_mfma_f32_32x32x16_bf16 v[40:55], v[28:31], a[24:27], v[40:55]
    v_mfma_f32_32x32x16_bf16 v[56:71], v[28:31], a[28:31], v[56:71]
    s_waitcnt lgkmcnt(0)
    s_barrier
    ds_read_b32 v88, v32
    ds_read_b128 v[24:27], v34 offset:0
    ds_read_b128 v[28:31], v34 offset:512
    ds_read_b128 v[8:11], v33 offset:0
    ds_read_b128 v[12:15], v33 offset:16
    ds_read_b128 v[16:19], v33 offset:32
    ds_read_b128 v[20:23], v33 offset:48
    v_mov_b32 v4, v35
    s_waitcnt lgkmcnt(6)
    v_mov_b32 v89, v88
    v_mov_b32 v90, v88
    v_mov_b32 v91, v88
    s_waitcnt lgkmcnt(4)
    s_nop 0
    v_mfma_f32_32x32x16_bf16 v[40:55], v[88:91], v[24:27], v[40:55]
    v_mfma_f32_32x32x16_bf16 v[56:71], v[88:91], v[28:31], v[56:71]
    s_lshl_b32 s12, s5, 4
    s_add_u32 s12, s12, s4
    s_lshl_b32 s16, s12, 9
    s_add_u32 s16, s16, 16777216
    v_lshlrev_b32 v72, 4, v94
    v_lshlrev_b32 v73, 3, v94
    v_add_u32 v73, 152576, v73
    v_lshlrev_b32 v74, 9, v95
    v_sub_u32 v74, v72, v74
    v_add_u32 v75, 512, v74
    v_add_u32 v74, 1536, v74
    s_lshl_b32 s12, s3, 11
    s_add_u32 s12, s12, 2048
    s_sub_u32 s17, s16, s12
    s_waitcnt lgkmcnt(0)
    v_mul_f32 v40, v40, v8
    v_mul_f32 v41, v41, v9
    v_mul_f32 v42, v42, v10
    v_mul_f32 v43, v43, v11
    v_mul_f32 v44, v44, v12
    v_mul_f32 v45, v45, v13
    v_mul_f32 v46, v46, v14
    v_mul_f32 v47, v47, v15
    v_mul_f32 v48, v48, v16
    v_mul_f32 v49, v49, v17
    v_mul_f32 v50, v50, v18
    v_mul_f32 v51, v51, v19
    v_mul_f32 v52, v52, v20
    v_mul_f32 v53, v53, v21
    v_mul_f32 v54, v54, v22
    v_mul_f32 v55, v55, v23
    v_mul_f32 v56, v56, v8
    v_mul_f32 v57, v57, v9
    v_fmac_f32 v41, v96, v40
    v_fmac_f32 v57, v96, v56
    v_fmac_f32 v41, v98, v56
    v_fmac_f32 v57, v97, v40
    v_mul_f32 v58, v58, v10
    v_fmac_f32 v42, v96, v41
    v_fmac_f32 v58, v96, v57
    v_fmac_f32 v42, v98, v57
    v_fmac_f32 v58, v97, v41
    v_mul_f32 v59, v59, v11
    v_fmac_f32 v43, v96, v42
    v_fmac_f32 v59, v96, v58
    v_fmac_f32 v43, v98, v58
    v_fmac_f32 v59, v97, v42
    v_mul_f32 v60, v60, v12
    v_fmac_f32 v44, v96, v43
    v_fmac_f32 v60, v96, v59
    v_fmac_f32 v44, v98, v59
    v_fmac_f32 v60, v97, v43
    v_mul_f32 v61, v61, v13
    v_fmac_f32 v45, v96, v44
    v_fmac_f32 v61, v96, v60
    v_fmac_f32 v45, v98, v60
    v_fmac_f32 v61, v97, v44
    v_mul_f32 v62, v62, v14
    v_fmac_f32 v46, v96, v45
    v_fmac_f32 v62, v96, v61
    v_fmac_f32 v46, v98, v61
    v_fmac_f32 v62, v97, v45
    v_mul_f32 v63, v63, v15
    v_fmac_f32 v47, v96, v46
    v_fmac_f32 v63, v96, v62
    v_fmac_f32 v47, v98, v62
    v_fmac_f32 v63, v97, v46
    v_mul_f32 v64, v64, v16
    v_fmac_f32 v48, v96, v47
    v_fmac_f32 v64, v96, v63
    v_fmac_f32 v48, v98, v63
    v_fmac_f32 v64, v97, v47
    v_mul_f32 v65, v65, v17
    v_fmac_f32 v49, v96, v48
    v_fmac_f32 v65, v96, v64
    v_fmac_f32 v49, v98, v64
    v_fmac_f32 v65, v97, v48
    v_mul_f32 v66, v66, v18
    v_fmac_f32 v50, v96, v49
    v_fmac_f32 v66, v96, v65
    v_fmac_f32 v50, v98, v65
    v_fmac_f32 v66, v97, v49
    v_mul_f32 v67, v67, v19
    v_fmac_f32 v51, v96, v50
    v_fmac_f32 v67, v96, v66
    v_fmac_f32 v51, v98, v66
    v_fmac_f32 v67, v97, v50
    v_mul_f32 v68, v68, v20
    v_fmac_f32 v52, v96, v51
    v_fmac_f32 v68, v96, v67
    v_fmac_f32 v52, v98, v67
    v_fmac_f32 v68, v97, v51
    v_mul_f32 v69, v69, v21
    v_fmac_f32 v53, v96, v52
    v_fmac_f32 v69, v96, v68
    v_fmac_f32 v53, v98, v68
    v_fmac_f32 v69, v97, v52
    v_mul_f32 v70, v70, v22
    v_fmac_f32 v54, v96, v53
    v_fmac_f32 v70, v96, v69
    v_fmac_f32 v54, v98, v69
    v_fmac_f32 v70, v97, v53
    v_mul_f32 v71, v71, v23
    v_fmac_f32 v55, v96, v54
    v_fmac_f32 v71, v96, v70
    v_fmac_f32 v55, v98, v70
    v_fmac_f32 v71, v97, v54
    ds_write2_b32 v4, v55, v71 offset0:0 offset1:1
    s_mov_b64 exec, 1
    ds_add_u32 v6, v92 offset:0
    s_mov_b64 exec, -1
    s_cmp_eq_u32 s3, 0
    s_cbranch_scc0 S_NOPUB
    s_waitcnt lgkmcnt(0)
    s_mov_b32 s24, 0
SP_29:
    ds_read_b32 v76, v6 offset:0
    s_add_u32 s24, s24, 1
    s_waitcnt lgkmcnt(0)
    v_readfirstlane_b32 s15, v76
    s_cmp_gt_u32 s24, 200000
    s_cbranch_scc1 SD_30
    s_cmp_lt_u32 s15, 4
    s_cbranch_scc1 SP_29
SD_30:
    ds_read_b64 v[8:9], v73 offset:0
    ds_read_b64 v[10:11], v73 offset:256
    ds_read_b64 v[12:13], v73 offset:512
    ds_read_b64 v[14:15], v73 offset:768
    ds_read_b64 v[16:17], v73 offset:1024
    ds_read_b64 v[18:19], v73 offset:1280
    ds_read_b64 v[20:21], v73 offset:1536
    ds_read_b32 v24, v73 offset:1792
    ds_read_b32 v26, v73 offset:1796
    v_mov_b32 v25, s22
    v_mov_b32 v27, s22
    s_waitcnt lgkmcnt(0)
    v_fmac_f32 v10, v102, v8
    v_fmac_f32 v11, v102, v9
    v_fma_f32 v10, -v103, v9, v10
    v_fmac_f32 v11, v103, v8
    v_fmac_f32 v12, v102, v10
    v_fmac_f32 v13, v102, v11
    v_fma_f32 v12, -v103, v11, v12
    v_fmac_f32 v13, v103, v10
    v_fmac_f32 v14, v102, v12
    v_fmac_f32 v15, v102, v13
    v_fma_f32 v14, -v103, v13, v14
    v_fmac_f32 v15, v103, v12
    v_fmac_f32 v16, v102, v14
    v_fmac_f32 v17, v102, v15
    v_fma_f32 v16, -v103, v15, v16
    v_fmac_f32 v17, v103, v14
    v_fmac_f32 v18, v102, v16
    v_fmac_f32 v19, v102, v17
    v_fma_f32 v18, -v103, v17, v18
    v_fmac_f32 v19, v103, v16
    v_fmac_f32 v20, v102, v18
    v_fmac_f32 v21, v102, v19
    v_fma_f32 v20, -v103, v19, v20
    v_fmac_f32 v21, v103, v18
    v_fmac_f32 v24, v102, v20
    v_fmac_f32 v26, v102, v21
    v_fma_f32 v24, -v103, v21, v24
    v_fmac_f32 v26, v103, v20
    s_mov_b64 exec, 0xffffffff
    buffer_store_dwordx4 v[24:27], v72, s[60:63], s16 offen sc1
    s_mov_b64 exec, -1
S_NOPUB:
    s_lshl_b32 s12, s3, 2
    v_add_u32 v76, s12, v95
    v_cmp_gt_u32 s[34:35], s4, v76
    v_add_u32 v76, 2, v76
    v_cmp_gt_u32 s[36:37], s4, v76
    s_and_b32 s13, s3, 1
    s_lshl_b32 s13, s13, 6
    v_xor_b32 v1, s13, v1
    v_xor_b32 v7, 64, v1
    s_lshl_b32 s33, s3, 14
    s_lshl_b32 s12, s6, 7
    s_add_u32 s33, s33, s12
    s_min_u32 s20, s3, 2
    s_lshl_b32 s20, s20, 11
    s_add_u32 s20, s20, 156672
    v_mul_f32 v88, v100, v40
    v_mul_f32 v89, v101, v40
    v_fma_f32 v40, -v101, v56, v88
    v_fma_f32 v56, -v100, v56, -v89
    s_add_u32 s12, s10, 0
    s_bitcmp1_b32 s12, 0
    s_cselect_b64 s[52:53], s[74:75], s[72:73]
    s_and_b32 s12, s12, 2
    s_lshl_b32 s12, s12, 6
    s_add_u32 m0, s28, 0
    s_add_u32 s39, s18, s12
    buffer_load_dwordx4 v1, s[52:55], s39 offen offset:0 lds
    v_mul_f32 v88, v100, v41
    v_mul_f32 v89, v101, v41
    v_fma_f32 v41, -v101, v57, v88
    v_fma_f32 v57, -v100, v57, -v89
    s_add_u32 s39, s39, 7168
    buffer_load_dwordx4 v7, s[52:55], s39 offen offset:1024 lds
    v_mul_f32 v88, v100, v42
    v_mul_f32 v89, v101, v42
    v_fma_f32 v42, -v101, v58, v88
    v_fma_f32 v58, -v100, v58, -v89
    s_add_u32 s39, s39, 7168
    buffer_load_dwordx4 v1, s[52:55], s39 offen offset:2048 lds
    v_mul_f32 v88, v100, v43
    v_mul_f32 v89, v101, v43
    v_fma_f32 v43, -v101, v59, v88
    v_fma_f32 v59, -v100, v59, -v89
    s_add_u32 s39, s39, 7168
    buffer_load_dwordx4 v7, s[52:55], s39 offen offset:3072 lds
    v_mul_f32 v88, v100, v44
    v_mul_f32 v89, v101, v44
    v_fma_f32 v44, -v101, v60, v88
    v_fma_f32 v60, -v100, v60, -v89
    s_add_u32 s12, s10, 0
    s_bitcmp1_b32 s12, 0
    s_cselect_b64 s[52:53], s[74:75], s[72:73]
    s_and_b32 s12, s12, 2
    s_lshl_b32 s12, s12, 6
    s_add_u32 m0, s28, 4096
    s_add_u32 s39, s23, s12
    buffer_load_dwordx4 v1, s[52:55], s39 offen offset:0 lds
    v_mul_f32 v88, v100, v45
    v_mul_f32 v89, v101, v45
    v_fma_f32 v45, -v101, v61, v88
    v_fma_f32 v61, -v100, v61, -v89
    s_add_u32 s39, s39, 7168
    buffer_load_dwordx4 v7, s[52:55], s39 offen offset:1024 lds
    v_mul_f32 v88, v100, v46
    v_mul_f32 v89, v101, v46
    v_fma_f32 v46, -v101, v62, v88
    v_fma_f32 v62, -v100, v62, -v89
    s_add_u32 s39, s39, 7168
    buffer_load_dwordx4 v1, s[52:55], s39 offen offset:2048 lds
    v_mul_f32 v88, v100, v47
    v_mul_f32 v89, v101, v47
    v_fma_f32 v47, -v101, v63, v88
    v_fma_f32 v63, -v100, v63, -v89
    s_add_u32 s39, s39, 7168
    buffer_load_dwordx4 v7, s[52:55], s39 offen offset:3072 lds
    v_mul_f32 v88, v100, v48
    v_mul_f32 v89, v101, v48
    v_fma_f32 v48, -v101, v64, v88
    v_fma_f32 v64, -v100, v64, -v89
    s_add_u32 s12, s10, 1
    s_bitcmp1_b32 s12, 0
    s_cselect_b64 s[52:53], s[74:75], s[72:73]
    s_and_b32 s12, s12, 2
    s_lshl_b32 s12, s12, 6
    s_add_u32 m0, s29, 0
    s_add_u32 s39, s18, s12
    buffer_load_dwordx4 v1, s[52:55], s39 offen offset:0 lds
    v_mul_f32 v88, v100, v49
    v_mul_f32 v89, v101, v49
    v_fma_f32 v49, -v101, v65, v88
    v_fma_f32 v65, -v100, v65, -v89
    s_add_u32 s39, s39, 7168
    buffer_load_dwordx4 v7, s[52:55], s39 offen offset:1024 lds
    v_mul_f32 v88, v100, v50
    v_mul_f32 v89, v101, v50
    v_fma_f32 v50, -v101, v66, v88
    v_fma_f32 v66, -v100, v66, -v89
    s_add_u32 s39, s39, 7168
    buffer_load_dwordx4 v1, s[52:55], s39 offen offset:2048 lds
    v_mul_f32 v88, v100, v51
    v_mul_f32 v89, v101, v51
    v_fma_f32 v51, -v101, v67, v88
    v_fma_f32 v67, -v100, v67, -v89
    s_add_u32 s39, s39, 7168
    buffer_load_dwordx4 v7, s[52:55], s39 offen offset:3072 lds
    v_mul_f32 v88, v100, v52
    v_mul_f32 v89, v101, v52
    v_fma_f32 v52, -v101, v68, v88
    v_fma_f32 v68, -v100, v68, -v89
    s_add_u32 m0, s20, 0
    s_add_u32 s13, s33, 1376256
    buffer_load_dwordx4 v5, s[56:59], s13 offen lds
    s_add_u32 s13, s13, 7168
    buffer_load_dwordx4 v5, s[56:59], s13 offen offset:1024 lds
    v_mul_f32 v88, v100, v53
    v_mul_f32 v89, v101, v53
    v_fma_f32 v53, -v101, v69, v88
    v_fma_f32 v69, -v100, v69, -v89
    v_mul_f32 v88, v100, v54
    v_mul_f32 v89, v101, v54
    v_fma_f32 v54, -v101, v70, v88
    v_fma_f32 v70, -v100, v70, -v89
    v_mul_f32 v88, v100, v55
    v_mul_f32 v89, v101, v55
    v_fma_f32 v55, -v101, v71, v88
    v_fma_f32 v71, -v100, v71, -v89
    v_lshrrev_b32 v16, 4, v0
    v_bfe_u32 v36, v16, 2, 2
    v_lshrrev_b32 v37, 5, v16
    v_lshl_add_u32 v36, v37, 2, v36
    v_lshlrev_b32 v36, 7, v36
    v_bfe_u32 v37, v16, 3, 1
    v_lshl_add_u32 v36, v37, 6, v36
    v_bfe_u32 v37, v16, 4, 1
    v_lshl_add_u32 v36, v37, 5, v36
    v_and_b32 v37, 3, v16
    v_lshl_add_u32 v36, v37, 3, v36
    s_and_b32 s12, s3, 1
    s_lshl_b32 s12, s12, 6
    v_xor_b32 v36, s12, v36
    s_add_u32 s12, s29, 2048
    s_cmp_gt_u32 s3, 1
    s_cselect_b32 s12, s12, s20
    v_add_u32 v38, s12, v36
    v_xor_b32 v39, 64, v38
    v_add_u32 v36, s29, v36
    v_xor_b32 v37, 64, v36
    v_lshrrev_b32 v16, 1, v94
    v_and_b32 v16, 7, v16
    v_xor_b32 v16, v16, v95
    v_lshlrev_b32 v16, 4, v16
    v_lshl_add_u32 v16, v94, 7, v16
    v_add_u32 v24, s28, v16
    v_xor_b32 v25, 32, v24
    v_xor_b32 v26, 64, v24
    v_xor_b32 v27, 96, v24
    v_add_u32 v28, s29, v16
    v_xor_b32 v29, 32, v28
    v_xor_b32 v30, 64, v28
    v_xor_b32 v31, 96, v28
    v_mul_f32 v88, v102, v102
    v_add_f32 v89, v102, v102
    v_fma_f32 v88, -v103, v103, v88
    v_mul_f32 v89, v89, v103
    v_mul_f32 v90, v88, v88
    v_add_f32 v91, v88, v88
    v_fma_f32 v90, -v89, v89, v90
    v_mul_f32 v91, v91, v89
    v_mul_f32 v76, v90, v90
    v_add_f32 v77, v90, v90
    v_fma_f32 v76, -v91, v91, v76
    v_mul_f32 v77, v77, v91
    v_mul_f32 v78, v76, v76
    v_add_f32 v79, v76, v76
    v_fma_f32 v78, -v77, v77, v78
    v_mul_f32 v79, v79, v77
    v_cmp_eq_u32 vcc, 0, v95
    s_nop 1
    v_cndmask_b32 v90, v76, 1.0, vcc
    v_cndmask_b32 v91, v77, 0, vcc
    v_mul_f32 v88, v78, v78
    v_add_f32 v89, v78, v78
    v_fma_f32 v88, -v79, v79, v88
    v_mul_f32 v89, v89, v79
    s_bitcmp1_b32 s3, 0
    s_cbranch_scc0 S_W1
    v_mul_f32 v76, v90, v88
    v_mul_f32 v77, v90, v89
    v_fma_f32 v76, -v91, v89, v76
    v_fmac_f32 v77, v91, v88
    v_mov_b32 v90, v76
    v_mov_b32 v91, v77
S_W1:
    s_bitcmp1_b32 s3, 1
    s_cbranch_scc0 S_W2
    v_mul_f32 v76, v88, v88
    v_add_f32 v77, v88, v88
    v_fma_f32 v76, -v89, v89, v76
    v_mul_f32 v77, v77, v89
    v_mul_f32 v88, v90, v76
    v_mul_f32 v89, v90, v77
    v_fma_f32 v88, -v91, v77, v88
    v_fmac_f32 v89, v91, v76
    v_mov_b32 v90, v88
    v_mov_b32 v91, v89
S_W2:
    s_mov_b32 s24, 0
SP_31:
    ds_read_b32 v93, v6 offset:0
    s_add_u32 s24, s24, 1
    s_waitcnt lgkmcnt(0)
    v_readfirstlane_b32 s15, v93
    s_cmp_gt_u32 s24, 200000
    s_cbranch_scc1 SD_32
    s_cmp_lt_u32 s15, 4
    s_cbranch_scc1 SP_31
SD_32:
    ds_read_b64 v[8:9], v73 offset:0
    ds_read_b64 v[10:11], v73 offset:256
    ds_read_b64 v[12:13], v73 offset:512
    ds_read_b64 v[14:15], v73 offset:768
    ds_read_b64 v[16:17], v73 offset:1024
    ds_read_b64 v[18:19], v73 offset:1280
    s_lshl_b32 s12, s3, 9
    v_add_u32 v93, s12, v73
    ds_read_b64 v[20:21], v93
    v_mov_b32 v76, 0
    v_mov_b32 v77, 0
    v_mov_b32 v88, 1.0
    v_mov_b32 v89, 0
    s_waitcnt lgkmcnt(0)
    s_cmp_le_u32 s3, 0
    s_cbranch_scc1 S_HD
    v_fmac_f32 v8, v102, v76
    v_fmac_f32 v9, v102, v77
    v_fma_f32 v8, -v103, v77, v8
    v_fmac_f32 v9, v103, v76
    v_fmac_f32 v10, v102, v8
    v_fmac_f32 v11, v102, v9
    v_fma_f32 v10, -v103, v9, v10
    v_fmac_f32 v11, v103, v8
    v_mov_b32 v76, v10
    v_mov_b32 v77, v11
    v_mul_f32 v22, v102, v88
    v_mul_f32 v23, v102, v89
    v_fma_f32 v22, -v103, v89, v22
    v_fmac_f32 v23, v103, v88
    v_mul_f32 v88, v102, v22
    v_mul_f32 v89, v102, v23
    v_fma_f32 v88, -v103, v23, v88
    v_fmac_f32 v89, v103, v22
    s_cmp_le_u32 s3, 1
    s_cbranch_scc1 S_HD
    v_fmac_f32 v12, v102, v76
    v_fmac_f32 v13, v102, v77
    v_fma_f32 v12, -v103, v77, v12
    v_fmac_f32 v13, v103, v76
    v_fmac_f32 v14, v102, v12
    v_fmac_f32 v15, v102, v13
    v_fma_f32 v14, -v103, v13, v14
    v_fmac_f32 v15, v103, v12
    v_mov_b32 v76, v14
    v_mov_b32 v77, v15
    v_mul_f32 v22, v102, v88
    v_mul_f32 v23, v102, v89
    v_fma_f32 v22, -v103, v89, v22
    v_fmac_f32 v23, v103, v88
    v_mul_f32 v88, v102, v22
    v_mul_f32 v89, v102, v23
    v_fma_f32 v88, -v103, v23, v88
    v_fmac_f32 v89, v103, v22
    s_cmp_le_u32 s3, 2
    s_cbranch_scc1 S_HD
    v_fmac_f32 v16, v102, v76
    v_fmac_f32 v17, v102, v77
    v_fma_f32 v16, -v103, v77, v16
    v_fmac_f32 v17, v103, v76
    v_fmac_f32 v18, v102, v16
    v_fmac_f32 v19, v102, v17
    v_fma_f32 v18, -v103, v17, v18
    v_fmac_f32 v19, v103, v16
    v_mov_b32 v76, v18
    v_mov_b32 v77, v19
    v_mul_f32 v22, v102, v88
    v_mul_f32 v23, v102, v89
    v_fma_f32 v22, -v103, v89, v22
    v_fmac_f32 v23, v103, v88
    v_mul_f32 v88, v102, v22
    v_mul_f32 v89, v102, v23
    v_fma_f32 v88, -v103, v23, v88
    v_fmac_f32 v89, v103, v22
S_HD:
    v_fmac_f32 v20, v102, v76
    v_fmac_f32 v21, v102, v77
    v_fma_f32 v20, -v103, v77, v20
    v_fmac_f32 v21, v103, v76
    v_mul_f32 v22, v102, v88
    v_mul_f32 v23, v102, v89
    v_fma_f32 v22, -v103, v89, v22
    v_fmac_f32 v23, v103, v88
    v_cmp_eq_u32 vcc, 0, v95
    s_nop 1
    v_cndmask_b32 v76, v20, v76, vcc
    v_cndmask_b32 v77, v21, v77, vcc
    v_cndmask_b32 v88, v22, v88, vcc
    v_cndmask_b32 v89, v23, v89, vcc
    v_mov_b32 v8, v96
    v_mov_b32 v104, v97
    v_mul_f32 v9, v96, v8
    v_mul_f32 v105, v96, v104
    v_fma_f32 v9, -v97, v104, v9
    v_fmac_f32 v105, v97, v8
    v_mul_f32 v10, v96, v9
    v_mul_f32 v106, v96, v105
    v_fma_f32 v10, -v97, v105, v10
    v_fmac_f32 v106, v97, v9
    v_mul_f32 v11, v96, v10
    v_mul_f32 v107, v96, v106
    v_fma_f32 v11, -v97, v106, v11
    v_fmac_f32 v107, v97, v10
    v_mul_f32 v12, v96, v11
    v_mul_f32 v108, v96, v107
    v_fma_f32 v12, -v97, v107, v12
    v_fmac_f32 v108, v97, v11
    v_mul_f32 v13, v96, v12
    v_mul_f32 v109, v96, v108
    v_fma_f32 v13, -v97, v108, v13
    v_fmac_f32 v109, v97, v12
    v_mul_f32 v14, v96, v13
    v_mul_f32 v110, v96, v109
    v_fma_f32 v14, -v97, v109, v14
    v_fmac_f32 v110, v97, v13
    v_mul_f32 v15, v96, v14
    v_mul_f32 v111, v96, v110
    v_fma_f32 v15, -v97, v110, v15
    v_fmac_f32 v111, v97, v14
    v_mul_f32 v16, v96, v15
    v_mul_f32 v112, v96, v111
    v_fma_f32 v16, -v97, v111, v16
    v_fmac_f32 v112, v97, v15
    v_mul_f32 v17, v96, v16
    v_mul_f32 v113, v96, v112
    v_fma_f32 v17, -v97, v112, v17
    v_fmac_f32 v113, v97, v16
    v_mul_f32 v18, v96, v17
    v_mul_f32 v114, v96, v113
    v_fma_f32 v18, -v97, v113, v18
    v_fmac_f32 v114, v97, v17
    v_mul_f32 v19, v96, v18
    v_mul_f32 v115, v96, v114
    v_fma_f32 v19, -v97, v114, v19
    v_fmac_f32 v115, v97, v18
    v_mul_f32 v20, v96, v19
    v_mul_f32 v116, v96, v115
    v_fma_f32 v20, -v97, v115, v20
    v_fmac_f32 v116, v97, v19
    v_mul_f32 v21, v96, v20
    v_mul_f32 v117, v96, v116
    v_fma_f32 v21, -v97, v116, v21
    v_fmac_f32 v117, v97, v20
    v_mul_f32 v22, v96, v21
    v_mul_f32 v118, v96, v117
    v_fma_f32 v22, -v97, v117, v22
    v_fmac_f32 v118, v97, v21
    v_mul_f32 v23, v96, v22
    v_mul_f32 v119, v96, v118
    v_fma_f32 v23, -v97, v118, v23
    v_fmac_f32 v119, v97, v22
    s_setprio 2
    buffer_load_dwordx4 v[80:83], v74, s[60:63], s17 offen sc1
    buffer_load_dwordx4 v[84:87], v75, s[60:63], s17 offen sc1
    v_lshrrev_b32 v72, 2, v94
    v_and_b32 v72, 3, v72
    v_lshlrev_b32 v73, 1, v95
    v_xor_b32 v72, v72, v73
    v_lshlrev_b32 v72, 4, v72
    v_lshl_add_u32 v72, v94, 6, v72
    v_add_u32 v72, s29, v72
    v_xor_b32 v73, 16, v72
    v_lshrrev_b32 v4, 4, v0
    v_and_b32 v2, 1, v4
    v_lshlrev_b32 v2, 1, v2
    v_bfe_u32 v3, v4, 4, 1
    v_or_b32 v2, v2, v3
    v_lshlrev_b32 v3, 1, v95
    v_xor_b32 v2, v2, v3
    v_lshlrev_b32 v2, 4, v2
    v_bfe_u32 v3, v4, 1, 1
    v_lshl_add_u32 v2, v3, 3, v2
    v_bfe_u32 v3, v4, 2, 2
    v_lshl_add_u32 v2, v3, 6, v2
    v_lshl_add_u32 v2, v95, 9, v2
    v_add_u32 v2, s29, v2
    v_xor_b32 v3, 16, v2
    v_lshlrev_b32 v4, 5, v94
    v_add_u32 v4, 154624, v4
    s_lshl_b32 s12, s3, 3
    v_add_u32 v120, s12, v4
    s_lshl_b32 s12, s5, 12
    s_add_u32 s12, s12, 88064
    s_add_u32 s14, s12, s30
    s_mov_b32 s24, 0
    s_waitcnt vmcnt(0)
S_GL:
    v_cmp_eq_u32 vcc, s22, v81
    v_cmp_eq_u32 s[44:45], s22, v83
    s_nop 0
    s_and_b64 s[44:45], s[44:45], vcc
    s_orn2_b64 s[44:45], s[44:45], s[34:35]
    v_cmp_eq_u32 vcc, s22, v85
    v_cmp_eq_u32 s[46:47], s22, v87
    s_nop 0
    s_and_b64 s[46:47], s[46:47], vcc
    s_orn2_b64 s[46:47], s[46:47], s[36:37]
    s_and_b64 s[44:45], s[44:45], s[46:47]
    s_cmp_eq_u64 s[44:45], -1
    s_cbranch_scc1 S_GOK
    s_add_u32 s24, s24, 1
    s_cmp_gt_u32 s24, 200000
    s_cbranch_scc1 S_GOK
    buffer_load_dwordx4 v[80:83], v74, s[60:63], s17 offen sc1
    buffer_load_dwordx4 v[84:87], v75, s[60:63], s17 offen sc1
    s_waitcnt vmcnt(0)
    s_branch S_GL
S_GOK:
    v_cndmask_b32 v80, 0, v80, s[34:35]
    v_cndmask_b32 v82, 0, v82, s[34:35]
    v_cndmask_b32 v84, 0, v84, s[36:37]
    v_cndmask_b32 v86, 0, v86, s[36:37]
    v_fmac_f32 v80, v78, v84
    v_fmac_f32 v82, v78, v86
    v_fma_f32 v80, -v79, v86, v80
    v_fmac_f32 v82, v79, v84
    v_mul_f32 v84, v90, v80
    v_mul_f32 v85, v90, v82
    v_fma_f32 v84, -v91, v82, v84
    v_fmac_f32 v85, v91, v80
    v_mov_b32 v86, v84
    v_mov_b32 v87, v85
    s_nop 0
    v_permlane32_swap_b32 v84, v86
    v_permlane32_swap_b32 v85, v87
    v_add_f32 v84, v84, v86
    v_add_f32 v85, v85, v87
    ds_write_b64 v120, v[84:85]
    s_mov_b64 exec, 1
    ds_add_u32 v6, v92 offset:4
    s_mov_b64 exec, -1
    ds_read_b128 a[0:3], v24 offset:0
    ds_read_b128 a[8:11], v25 offset:0
    ds_read_b128 a[16:19], v26 offset:0
    ds_read_b128 a[24:27], v27 offset:0
    ds_read_b128 a[4:7], v24 offset:4096
    ds_read_b128 a[12:15], v25 offset:4096
    ds_read_b128 a[20:23], v26 offset:4096
    ds_read_b128 a[28:31], v27 offset:4096
    ds_read_b128 a[32:35], v28 offset:0
    ds_read_b128 a[40:43], v29 offset:0
    ds_read_b128 a[48:51], v30 offset:0
    ds_read_b128 a[56:59], v31 offset:0
    s_waitcnt lgkmcnt(0)
    s_mov_b32 s24, 0
SP_33:
    ds_read_b32 v93, v6 offset:4
    s_add_u32 s24, s24, 1
    s_waitcnt lgkmcnt(0)
    v_readfirstlane_b32 s15, v93
    s_cmp_gt_u32 s24, 200000
    s_cbranch_scc1 SD_34
    s_cmp_lt_u32 s15, 4
    s_cbranch_scc1 SP_33
SD_34:
    ds_read_b128 v[80:83], v4
    ds_read_b128 v[84:87], v4 offset:16
    s_waitcnt lgkmcnt(0)
    v_add_f32 v80, v80, v82
    v_add_f32 v81, v81, v83
    v_add_f32 v84, v84, v86
    v_add_f32 v85, v85, v87
    v_add_f32 v80, v80, v84
    v_add_f32 v81, v81, v85
    v_fmac_f32 v76, v88, v80
    v_fmac_f32 v77, v88, v81
    v_fma_f32 v76, -v89, v81, v76
    v_fmac_f32 v77, v89, v80
    v_mul_f32 v80, v100, v76
    v_mul_f32 v81, v100, v77
    v_fma_f32 v80, -v101, v77, v80
    v_fmac_f32 v81, v101, v76
    v_fmac_f32 v40, v8, v80
    v_fma_f32 v56, -v8, v81, v56
    v_fma_f32 v40, -v104, v81, v40
    v_fma_f32 v56, -v104, v80, v56
    v_fmac_f32 v41, v9, v80
    v_fma_f32 v57, -v9, v81, v57
    v_fma_f32 v41, -v105, v81, v41
    v_fma_f32 v57, -v105, v80, v57
    v_fmac_f32 v42, v10, v80
    v_fma_f32 v58, -v10, v81, v58
    v_fma_f32 v42, -v106, v81, v42
    v_fma_f32 v58, -v106, v80, v58
    v_fmac_f32 v43, v11, v80
    v_fma_f32 v59, -v11, v81, v59
    v_fma_f32 v43, -v107, v81, v43
    v_fma_f32 v59, -v107, v80, v59
    v_fmac_f32 v44, v12, v80
    v_fma_f32 v60, -v12, v81, v60
    v_fma_f32 v44, -v108, v81, v44
    v_fma_f32 v60, -v108, v80, v60
    v_fmac_f32 v45, v13, v80
    v_fma_f32 v61, -v13, v81, v61
    v_fma_f32 v45, -v109, v81, v45
    v_fma_f32 v61, -v109, v80, v61
    v_fmac_f32 v46, v14, v80
    v_fma_f32 v62, -v14, v81, v62
    v_fma_f32 v46, -v110, v81, v46
    v_fma_f32 v62, -v110, v80, v62
    v_fmac_f32 v47, v15, v80
    v_fma_f32 v63, -v15, v81, v63
    v_fma_f32 v47, -v111, v81, v47
    v_fma_f32 v63, -v111, v80, v63
    v_fmac_f32 v48, v16, v80
    v_fma_f32 v64, -v16, v81, v64
    v_fma_f32 v48, -v112, v81, v48
    v_fma_f32 v64, -v112, v80, v64
    v_fmac_f32 v49, v17, v80
    v_fma_f32 v65, -v17, v81, v65
    v_fma_f32 v49, -v113, v81, v49
    v_fma_f32 v65, -v113, v80, v65
    v_fmac_f32 v50, v18, v80
    v_fma_f32 v66, -v18, v81, v66
    v_fma_f32 v50, -v114, v81, v50
    v_fma_f32 v66, -v114, v80, v66
    v_fmac_f32 v51, v19, v80
    v_fma_f32 v67, -v19, v81, v67
    v_fma_f32 v51, -v115, v81, v51
    v_fma_f32 v67, -v115, v80, v67
    v_fmac_f32 v52, v20, v80
    v_fma_f32 v68, -v20, v81, v68
    v_fma_f32 v52, -v116, v81, v52
    v_fma_f32 v68, -v116, v80, v68
    v_fmac_f32 v53, v21, v80
    v_fma_f32 v69, -v21, v81, v69
    v_fma_f32 v53, -v117, v81, v53
    v_fma_f32 v69, -v117, v80, v69
    v_fmac_f32 v54, v22, v80
    v_fma_f32 v70, -v22, v81, v70
    v_fma_f32 v54, -v118, v81, v54
    v_fma_f32 v70, -v118, v80, v70
    v_fmac_f32 v55, v23, v80
    v_fma_f32 v71, -v23, v81, v71
    v_fma_f32 v55, -v119, v81, v55
    v_fma_f32 v71, -v119, v80, v71
    v_cvt_pk_bf16_f32 v8, v40, v41
    v_cvt_pk_bf16_f32 v9, v42, v43
    v_cvt_pk_bf16_f32 v10, v44, v45
    v_cvt_pk_bf16_f32 v11, v46, v47
    v_cvt_pk_bf16_f32 v12, v48, v49
    v_cvt_pk_bf16_f32 v13, v50, v51
    v_cvt_pk_bf16_f32 v14, v52, v53
    v_cvt_pk_bf16_f32 v15, v54, v55
    v_cvt_pk_bf16_f32 v16, v56, v57
    v_cvt_pk_bf16_f32 v17, v58, v59
    v_cvt_pk_bf16_f32 v18, v60, v61
    v_cvt_pk_bf16_f32 v19, v62, v63
    v_cvt_pk_bf16_f32 v20, v64, v65
    v_cvt_pk_bf16_f32 v21, v66, v67
    v_cvt_pk_bf16_f32 v22, v68, v69
    v_cvt_pk_bf16_f32 v23, v70, v71
    ds_write_b128 v72, v[8:11] offset:0
    ds_write_b128 v73, v[12:15] offset:0
    ds_write_b128 v72, v[16:19] offset:2048
    ds_write_b128 v73, v[20:23] offset:2048
    ds_read_b64_tr_b16 v[40:41], v2 offset:0
    ds_read_b64_tr_b16 v[42:43], v3 offset:256
    ds_read_b64_tr_b16 v[44:45], v2 offset:1024
    ds_read_b64_tr_b16 v[46:47], v3 offset:1280
    ds_read_b64_tr_b16 v[48:49], v2 offset:2048
    ds_read_b64_tr_b16 v[50:51], v3 offset:2304
    ds_read_b64_tr_b16 v[52:53], v2 offset:3072
    ds_read_b64_tr_b16 v[54:55], v3 offset:3328
    s_lshl_b32 s13, s4, 1
    s_lshr_b32 s12, s3, 1
    s_add_u32 s13, s13, s12
    s_lshl_b32 s13, s13, 12
    s_add_u32 s11, s13, 17825792
    s_lshl_b32 s13, s5, 1
    s_and_b32 s12, s3, 1
    s_add_u32 s13, s13, s12
    s_lshl_b32 s13, s13, 2
    s_add_u32 s11, s11, s13
    s_lshr_b32 s12, s5, 2
    s_add_u32 s12, s12, 8
    s_lshl_b32 s12, s12, 8
    s_add_u32 s11, s11, s12
    v_mov_b32 v56, s22
    v_mov_b32 v57, 0
    s_waitcnt lgkmcnt(6)
    buffer_store_dwordx4 v[40:43], v0, s[60:63], s14 offen offset:0 sc1
    s_waitcnt lgkmcnt(4)
    buffer_store_dwordx4 v[44:47], v0, s[60:63], s14 offen offset:1024 sc1
    s_waitcnt lgkmcnt(2)
    buffer_store_dwordx4 v[48:51], v0, s[60:63], s14 offen offset:2048 sc1
    s_waitcnt lgkmcnt(0)
    buffer_store_dwordx4 v[52:55], v0, s[60:63], s14 offen offset:3072 sc1
    s_mov_b64 exec, 1
    ds_add_u32 v6, v92 offset:20
    s_mov_b64 exec, -1
    s_waitcnt lgkmcnt(0)
    s_mov_b32 s24, 0
SP_35:
    ds_read_b32 v93, v6 offset:24
    s_add_u32 s24, s24, 1
    s_waitcnt lgkmcnt(0)
    v_readfirstlane_b32 s15, v93
    s_cmp_gt_u32 s24, 200000
    s_cbranch_scc1 SD_36
    s_cmp_lt_u32 s15, 4
    s_cbranch_scc1 SP_35
SD_36:
    s_add_u32 s12, s10, 1
    s_bitcmp1_b32 s12, 0
    s_cselect_b64 s[52:53], s[74:75], s[72:73]
    s_and_b32 s12, s12, 2
    s_lshl_b32 s12, s12, 6
    s_add_u32 m0, s28, 0
    s_add_u32 s39, s23, s12
    buffer_load_dwordx4 v1, s[52:55], s39 offen offset:0 lds
    s_add_u32 s39, s39, 7168
    buffer_load_dwordx4 v7, s[52:55], s39 offen offset:1024 lds
    s_add_u32 s39, s39, 7168
    buffer_load_dwordx4 v1, s[52:55], s39 offen offset:2048 lds
    s_add_u32 s39, s39, 7168
    buffer_load_dwordx4 v7, s[52:55], s39 offen offset:3072 lds
    s_add_u32 s12, s10, 2
    s_bitcmp1_b32 s12, 0
    s_cselect_b64 s[52:53], s[74:75], s[72:73]
    s_and_b32 s12, s12, 2
    s_lshl_b32 s12, s12, 6
    s_add_u32 m0, s28, 4096
    s_add_u32 s39, s18, s12
    buffer_load_dwordx4 v1, s[52:55], s39 offen offset:0 lds
    s_add_u32 s39, s39, 7168
    buffer_load_dwordx4 v7, s[52:55], s39 offen offset:1024 lds
    s_add_u32 s39, s39, 7168
    buffer_load_dwordx4 v1, s[52:55], s39 offen offset:2048 lds
    s_add_u32 s39, s39, 7168
    buffer_load_dwordx4 v7, s[52:55], s39 offen offset:3072 lds
    s_add_u32 s12, s10, 2
    s_bitcmp1_b32 s12, 0
    s_cselect_b64 s[52:53], s[74:75], s[72:73]
    s_and_b32 s12, s12, 2
    s_lshl_b32 s12, s12, 6
    s_add_u32 m0, s29, 0
    s_add_u32 s39, s23, s12
    buffer_load_dwordx4 v1, s[52:55], s39 offen offset:0 lds
    s_add_u32 s39, s39, 7168
    buffer_load_dwordx4 v7, s[52:55], s39 offen offset:1024 lds
    s_add_u32 s39, s39, 7168
    buffer_load_dwordx4 v1, s[52:55], s39 offen offset:2048 lds
    s_add_u32 s39, s39, 7168
    buffer_load_dwordx4 v7, s[52:55], s39 offen offset:3072 lds
    ds_read_b64_tr_b16 v[120:121], v38 offset:0
    ds_read_b64_tr_b16 v[122:123], v38 offset:1024
    ds_read_b64_tr_b16 v[124:125], v39 offset:0
    ds_read_b64_tr_b16 v[126:127], v39 offset:1024
    v_lshrrev_b32 v2, 2, v0
    s_mov_b32 s36, s22
    s_mov_b32 s37, s22
    s_mul_i32 s12, s3, 288
    s_add_u32 s12, s12, 2048
    s_add_u32 s16, s32, s12
    s_add_u32 s32, s32, 1120
    s_waitcnt vmcnt(12)
    s_mov_b64 exec, 1
    buffer_store_dword v56, v57, s[60:63], s11 offen sc1
    s_mov_b64 exec, -1
    s_setprio 0
    s_waitcnt vmcnt(5)
    ds_read_b128 a[36:39], v24 offset:0
    ds_read_b128 a[44:47], v25 offset:0
    ds_read_b128 a[52:55], v26 offset:0
    ds_read_b128 a[60:63], v27 offset:0
    ds_read_b128 a[64:67], v24 offset:4096
    ds_read_b128 a[72:75], v25 offset:4096
    ds_read_b128 a[80:83], v26 offset:4096
    ds_read_b128 a[88:91], v27 offset:4096
    s_waitcnt lgkmcnt(4)
    s_add_u32 s12, s10, 3
    s_bitcmp1_b32 s12, 0
    s_cselect_b64 s[52:53], s[74:75], s[72:73]
    s_and_b32 s12, s12, 2
    s_lshl_b32 s12, s12, 6
    s_add_u32 m0, s28, 0
    s_add_u32 s39, s18, s12
    buffer_load_dwordx4 v1, s[52:55], s39 offen offset:0 lds
    s_add_u32 s39, s39, 7168
    buffer_load_dwordx4 v7, s[52:55], s39 offen offset:1024 lds
    s_add_u32 s39, s39, 7168
    buffer_load_dwordx4 v1, s[52:55], s39 offen offset:2048 lds
    s_add_u32 s39, s39, 7168
    buffer_load_dwordx4 v7, s[52:55], s39 offen offset:3072 lds
    s_waitcnt lgkmcnt(0)
    s_add_u32 s12, s10, 3
    s_bitcmp1_b32 s12, 0
    s_cselect_b64 s[52:53], s[74:75], s[72:73]
    s_and_b32 s12, s12, 2
    s_lshl_b32 s12, s12, 6
    s_add_u32 m0, s28, 4096
    s_add_u32 s39, s23, s12
    buffer_load_dwordx4 v1, s[52:55], s39 offen offset:0 lds
    s_add_u32 s39, s39, 7168
    buffer_load_dwordx4 v7, s[52:55], s39 offen offset:1024 lds
    s_add_u32 s39, s39, 7168
    buffer_load_dwordx4 v1, s[52:55], s39 offen offset:2048 lds
    s_add_u32 s39, s39, 7168
    buffer_load_dwordx4 v7, s[52:55], s39 offen offset:3072 lds
    s_waitcnt vmcnt(9)
    ds_read_b128 a[68:71], v28 offset:0
    ds_read_b128 a[76:79], v29 offset:0
    ds_read_b128 a[84:87], v30 offset:0
    ds_read_b128 a[92:95], v31 offset:0
    v_mov_b32 v60, v24
    v_mov_b32 v61, v25
    v_mov_b32 v62, v26
    v_mov_b32 v63, v27
    v_mov_b32 v64, v36
    v_mov_b32 v65, v37
    s_waitcnt lgkmcnt(0)
    s_add_u32 m0, s29, 0
    s_add_u32 s13, s33, 1245184
    buffer_load_dwordx4 v5, s[56:59], s13 offen lds
    s_add_u32 s13, s13, 7168
    buffer_load_dwordx4 v5, s[56:59], s13 offen offset:1024 lds
    s_add_u32 m0, s29, 2048
    s_add_u32 s13, s33, 1310720
    buffer_load_dwordx4 v5, s[56:59], s13 offen lds
    s_add_u32 s13, s13, 7168
    buffer_load_dwordx4 v5, s[56:59], s13 offen offset:1024 lds
    s_buffer_load_dwordx8 s[92:99], s[60:63], s16 glc
    s_lshr_b32 s12, s3, 1
    s_mul_i32 s12, s12, 153600
    s_sub_u32 s13, 153600, s12
    v_add_u32 v1, s12, v0
    v_add_u32 v5, s13, v0
    s_lshl_b32 s12, s3, 14
    s_add_u32 s12, s12, 88064
    s_add_u32 s33, s31, s12
    s_waitcnt lgkmcnt(0)
    s_xor_b64 s[92:93], s[92:93], s[36:37]
    s_xor_b64 s[94:95], s[94:95], s[36:37]
    s_xor_b64 s[96:97], s[96:97], s[36:37]
    s_xor_b64 s[98:99], s[98:99], s[36:37]
    s_or_b64 s[92:93], s[92:93], s[94:95]
    s_or_b64 s[92:93], s[92:93], s[96:97]
    s_or_b64 s[92:93], s[92:93], s[98:99]
    s_cbranch_scc1 PL_37
PD_38:
    s_add_u32 s12, s10, 0
    s_and_b32 s13, s12, 2
    s_lshl_b32 s13, s13, 12
    s_and_b32 s12, s12, 1
    s_lshl_b32 s12, s12, 11
    s_add_u32 s17, s33, s12
    s_add_u32 s17, s17, s13
    buffer_load_dwordx4 v[8:11], v1, s[60:63], s17 offen offset:0 sc1
    buffer_load_dwordx4 v[12:15], v5, s[60:63], s17 offen offset:0 sc1
    buffer_load_dwordx4 v[16:19], v1, s[60:63], s17 offen offset:1024 sc1
    buffer_load_dwordx4 v[20:23], v5, s[60:63], s17 offen offset:1024 sc1
    s_add_u32 s17, s17, 4096
    buffer_load_dwordx4 v[24:27], v1, s[60:63], s17 offen offset:0 sc1
    buffer_load_dwordx4 v[28:31], v5, s[60:63], s17 offen offset:0 sc1
    buffer_load_dwordx4 v[32:35], v1, s[60:63], s17 offen offset:1024 sc1
    buffer_load_dwordx4 v[36:39], v5, s[60:63], s17 offen offset:1024 sc1
    s_waitcnt vmcnt(12)
    ds_read_b128 a[96:99], v60 offset:0
    ds_read_b128 a[104:107], v61 offset:0
    ds_read_b128 a[112:115], v62 offset:0
    ds_read_b128 a[120:123], v63 offset:0
    ds_read_b128 a[100:103], v60 offset:4096
    ds_read_b128 a[108:111], v61 offset:4096
    ds_read_b128 a[116:119], v62 offset:4096
    ds_read_b128 a[124:127], v63 offset:4096
    s_waitcnt vmcnt(8)
    ds_read_b64_tr_b16 v[104:105], v64 offset:0
    ds_read_b64_tr_b16 v[106:107], v64 offset:1024
    ds_read_b64_tr_b16 v[108:109], v65 offset:0
    ds_read_b64_tr_b16 v[110:111], v65 offset:1024
    ds_read_b64_tr_b16 v[112:113], v64 offset:2048
    ds_read_b64_tr_b16 v[114:115], v64 offset:3072
    ds_read_b64_tr_b16 v[116:117], v65 offset:2048
    ds_read_b64_tr_b16 v[118:119], v65 offset:3072
    s_waitcnt lgkmcnt(0)
    s_waitcnt vmcnt(6)
    v_mfma_f32_32x32x16_bf16 v[40:55], v[8:11], a[0:3], 0
    v_mfma_f32_32x32x16_bf16 v[56:71], v[8:11], a[4:7], 0
    v_mfma_f32_32x32x16_bf16 v[72:87], v[12:15], a[0:3], 0
    v_mfma_f32_32x32x16_bf16 v[88:103], v[12:15], a[4:7], 0
    s_add_u32 s12, s10, 1
    s_and_b32 s13, s12, 2
    s_lshl_b32 s13, s13, 12
    s_and_b32 s12, s12, 1
    s_lshl_b32 s12, s12, 11
    s_add_u32 s17, s33, s12
    s_add_u32 s17, s17, s13
    buffer_load_dwordx4 v[8:11], v1, s[60:63], s17 offen offset:0 sc1
    buffer_load_dwordx4 v[12:15], v5, s[60:63], s17 offen offset:0 sc1
    buffer_load_dwordx4 a[0:3], v1, s[60:63], s17 offen offset:1024 sc1
    buffer_load_dwordx4 a[4:7], v5, s[60:63], s17 offen offset:1024 sc1
    s_waitcnt vmcnt(8)
    v_mfma_f32_32x32x16_bf16 v[40:55], v[16:19], a[8:11], v[40:55]
    v_mfma_f32_32x32x16_bf16 v[56:71], v[16:19], a[12:15], v[56:71]
    v_mfma_f32_32x32x16_bf16 v[72:87], v[20:23], a[8:11], v[72:87]
    v_mfma_f32_32x32x16_bf16 v[88:103], v[20:23], a[12:15], v[88:103]
    s_add_u32 s17, s17, 4096
    buffer_load_dwordx4 v[16:19], v1, s[60:63], s17 offen offset:0 sc1
    buffer_load_dwordx4 v[20:23], v5, s[60:63], s17 offen offset:0 sc1
    s_waitcnt vmcnt(8)
    v_mfma_f32_32x32x16_bf16 v[40:55], v[24:27], a[16:19], v[40:55]
    v_mfma_f32_32x32x16_bf16 v[56:71], v[24:27], a[20:23], v[56:71]
    v_mfma_f32_32x32x16_bf16 v[72:87], v[28:31], a[16:19], v[72:87]
    v_mfma_f32_32x32x16_bf16 v[88:103], v[28:31], a[20:23], v[88:103]
    buffer_load_dwordx4 a[8:11], v1, s[60:63], s17 offen offset:1024 sc1
    buffer_load_dwordx4 a[12:15], v5, s[60:63], s17 offen offset:1024 sc1
    s_waitcnt vmcnt(8)
    v_mfma_f32_32x32x16_bf16 v[40:55], v[32:35], a[24:27], v[40:55]
    v_mfma_f32_32x32x16_bf16 v[56:71], v[32:35], a[28:31], v[56:71]
    v_mfma_f32_32x32x16_bf16 v[72:87], v[36:39], a[24:27], v[72:87]
    v_mfma_f32_32x32x16_bf16 v[88:103], v[36:39], a[28:31], v[88:103]
    s_add_u32 s12, s10, 2
    s_and_b32 s13, s12, 2
    s_lshl_b32 s13, s13, 12
    s_and_b32 s12, s12, 1
    s_lshl_b32 s12, s12, 11
    s_add_u32 s17, s33, s12
    s_add_u32 s17, s17, s13
    buffer_load_dwordx4 v[24:27], v1, s[60:63], s17 offen offset:0 sc1
    buffer_load_dwordx4 v[28:31], v5, s[60:63], s17 offen offset:0 sc1
    s_buffer_load_dwordx8 s[92:99], s[60:63], s32 glc
    s_waitcnt vmcnt(8)
    v_mfma_f32_32x32x16_bf16 v[40:55], v[8:11], a[32:35], v[40:55]
    v_mfma_f32_32x32x16_bf16 v[56:71], v[8:11], a[36:39], v[56:71]
    v_mfma_f32_32x32x16_bf16 v[72:87], v[12:15], a[32:35], v[72:87]
    v_mfma_f32_32x32x16_bf16 v[88:103], v[12:15], a[36:39], v[88:103]
    buffer_load_dwordx4 a[16:19], v1, s[60:63], s17 offen offset:1024 sc1
    buffer_load_dwordx4 a[20:23], v5, s[60:63], s17 offen offset:1024 sc1
    s_waitcnt vmcnt(8)
    v_mfma_f32_32x32x16_bf16 v[40:55], a[0:3], a[40:43], v[40:55]
    v_mfma_f32_32x32x16_bf16 v[56:71], a[0:3], a[44:47], v[56:71]
    v_mfma_f32_32x32x16_bf16 v[72:87], a[4:7], a[40:43], v[72:87]
    v_mfma_f32_32x32x16_bf16 v[88:103], a[4:7], a[44:47], v[88:103]
    s_add_u32 s17, s17, 4096
    buffer_load_dwordx4 v[32:35], v1, s[60:63], s17 offen offset:0 sc1
    buffer_load_dwordx4 v[36:39], v5, s[60:63], s17 offen offset:0 sc1
    s_waitcnt vmcnt(8)
    v_mfma_f32_32x32x16_bf16 v[40:55], v[16:19], a[48:51], v[40:55]
    v_mfma_f32_32x32x16_bf16 v[56:71], v[16:19], a[52:55], v[56:71]
    v_mfma_f32_32x32x16_bf16 v[72:87], v[20:23], a[48:51], v[72:87]
    v_mfma_f32_32x32x16_bf16 v[88:103], v[20:23], a[52:55], v[88:103]
    buffer_load_dwordx4 a[24:27], v1, s[60:63], s17 offen offset:1024 sc1
    buffer_load_dwordx4 a[28:31], v5, s[60:63], s17 offen offset:1024 sc1
    s_waitcnt vmcnt(8)
    v_mfma_f32_32x32x16_bf16 v[40:55], a[8:11], a[56:59], v[40:55]
    v_mfma_f32_32x32x16_bf16 v[56:71], a[8:11], a[60:63], v[56:71]
    v_mfma_f32_32x32x16_bf16 v[72:87], a[12:15], a[56:59], v[72:87]
    v_mfma_f32_32x32x16_bf16 v[88:103], a[12:15], a[60:63], v[88:103]
    s_add_u32 s12, s10, 3
    s_and_b32 s13, s12, 2
    s_lshl_b32 s13, s13, 12
    s_and_b32 s12, s12, 1
    s_lshl_b32 s12, s12, 11
    s_add_u32 s17, s33, s12
    s_add_u32 s17, s17, s13
    buffer_load_dwordx4 v[8:11], v1, s[60:63], s17 offen offset:0 sc1
    buffer_load_dwordx4 v[12:15], v5, s[60:63], s17 offen offset:0 sc1
    s_waitcnt vmcnt(8)
    v_mfma_f32_32x32x16_bf16 v[40:55], v[24:27], a[64:67], v[40:55]
    v_mfma_f32_32x32x16_bf16 v[56:71], v[24:27], a[68:71], v[56:71]
    v_mfma_f32_32x32x16_bf16 v[72:87], v[28:31], a[64:67], v[72:87]
    v_mfma_f32_32x32x16_bf16 v[88:103], v[28:31], a[68:71], v[88:103]
    buffer_load_dwordx4 a[32:35], v1, s[60:63], s17 offen offset:1024 sc1
    buffer_load_dwordx4 a[36:39], v5, s[60:63], s17 offen offset:1024 sc1
    s_waitcnt vmcnt(8)
    v_mfma_f32_32x32x16_bf16 v[40:55], a[16:19], a[72:75], v[40:55]
    v_mfma_f32_32x32x16_bf16 v[56:71], a[16:19], a[76:79], v[56:71]
    v_mfma_f32_32x32x16_bf16 v[72:87], a[20:23], a[72:75], v[72:87]
    v_mfma_f32_32x32x16_bf16 v[88:103], a[20:23], a[76:79], v[88:103]
    s_add_u32 s17, s17, 4096
    buffer_load_dwordx4 a[0:3], v1, s[60:63], s17 offen offset:0 sc1
    buffer_load_dwordx4 a[4:7], v5, s[60:63], s17 offen offset:0 sc1
    s_waitcnt vmcnt(8)
    v_mfma_f32_32x32x16_bf16 v[40:55], v[32:35], a[80:83], v[40:55]
    v_mfma_f32_32x32x16_bf16 v[56:71], v[32:35], a[84:87], v[56:71]
    v_mfma_f32_32x32x16_bf16 v[72:87], v[36:39], a[80:83], v[72:87]
    v_mfma_f32_32x32x16_bf16 v[88:103], v[36:39], a[84:87], v[88:103]
    buffer_load_dwordx4 a[40:43], v1, s[60:63], s17 offen offset:1024 sc1
    buffer_load_dwordx4 a[44:47], v5, s[60:63], s17 offen offset:1024 sc1
    s_waitcnt vmcnt(8)
    v_mfma_f32_32x32x16_bf16 v[40:55], a[24:27], a[88:91], v[40:55]
    v_mfma_f32_32x32x16_bf16 v[56:71], a[24:27], a[92:95], v[56:71]
    v_mfma_f32_32x32x16_bf16 v[72:87], a[28:31], a[88:91], v[72:87]
    v_mfma_f32_32x32x16_bf16 v[88:103], a[28:31], a[92:95], v[88:103]
    s_waitcnt lgkmcnt(0)
    s_xor_b64 s[94:95], s[94:95], s[36:37]
    s_xor_b64 s[96:97], s[96:97], s[36:37]
    s_xor_b64 s[98:99], s[98:99], s[36:37]
    s_or_b64 s[94:95], s[94:95], s[96:97]
    s_or_b64 s[94:95], s[94:95], s[98:99]
    s_cbranch_scc1 PL_40
PD_41:
    s_add_u32 s12, s3, 76
    s_lshl_b32 s12, s12, 10
    s_add_u32 s17, s31, s12
    buffer_load_dwordx4 v[16:19], v1, s[60:63], s17 offen sc1
    buffer_load_dwordx4 v[20:23], v5, s[60:63], s17 offen sc1
    s_waitcnt vmcnt(8)
    v_mfma_f32_32x32x16_bf16 v[40:55], v[8:11], a[96:99], v[40:55]
    v_mfma_f32_32x32x16_bf16 v[56:71], v[8:11], a[100:103], v[56:71]
    v_mfma_f32_32x32x16_bf16 v[72:87], v[12:15], a[96:99], v[72:87]
    v_mfma_f32_32x32x16_bf16 v[88:103], v[12:15], a[100:103], v[88:103]
    s_add_u32 s17, s17, 4096
    buffer_load_dwordx4 a[48:51], v1, s[60:63], s17 offen sc1
    buffer_load_dwordx4 a[52:55], v5, s[60:63], s17 offen sc1
    ds_read_b32 v4, v6 offset:16
    s_waitcnt vmcnt(8)
    v_mfma_f32_32x32x16_bf16 v[40:55], a[32:35], a[104:107], v[40:55]
    v_mfma_f32_32x32x16_bf16 v[56:71], a[32:35], a[108:111], v[56:71]
    v_mfma_f32_32x32x16_bf16 v[72:87], a[36:39], a[104:107], v[72:87]
    v_mfma_f32_32x32x16_bf16 v[88:103], a[36:39], a[108:111], v[88:103]
    s_add_u32 s17, s17, 4096
    s_cmp_gt_u32 s3, 1
    s_cselect_b32 s17, 2130706432, s17
    buffer_load_dwordx4 a[8:11], v1, s[60:63], s17 offen sc1
    buffer_load_dwordx4 a[12:15], v5, s[60:63], s17 offen sc1
    s_waitcnt lgkmcnt(0)
    v_readfirstlane_b32 s15, v4
    s_nop 0
    s_cmp_lt_u32 s15, 4
    s_cbranch_scc1 CS_43
CB_44:
    v_add_u32 v2, s27, v0
    v_add_u32 v3, s28, v0
    v_add_u32 v4, s29, v0
    s_waitcnt vmcnt(8)
    v_mfma_f32_32x32x16_bf16 v[56:71], a[0:3], a[116:119], v[56:71]
    s_waitcnt vmcnt(6)
    v_mfma_f32_32x32x16_bf16 v[56:71], a[40:43], a[124:127], v[56:71]
    s_waitcnt vmcnt(4)
    v_mfma_f32_32x32x16_bf16 v[56:71], v[16:19], v[108:111], v[56:71]
    s_waitcnt vmcnt(2)
    v_mfma_f32_32x32x16_bf16 v[56:71], a[48:51], v[116:119], v[56:71]
    s_waitcnt vmcnt(0)
    v_mfma_f32_32x32x16_bf16 v[56:71], a[8:11], v[124:127], v[56:71]
    v_mfma_f32_32x32x16_bf16 v[72:87], a[4:7], a[112:115], v[72:87]
    v_mfma_f32_32x32x16_bf16 v[72:87], a[44:47], a[120:123], v[72:87]
    s_nop 9
    ds_write_b128 v3, v[56:59] offset:0
    v_mfma_f32_32x32x16_bf16 v[72:87], v[20:23], v[104:107], v[72:87]
    ds_write_b128 v3, v[60:63] offset:1024
    v_mfma_f32_32x32x16_bf16 v[72:87], a[52:55], v[112:115], v[72:87]
    ds_write_b128 v3, v[64:67] offset:2048
    v_mfma_f32_32x32x16_bf16 v[72:87], a[12:15], v[120:123], v[72:87]
    ds_write_b128 v3, v[68:71] offset:3072
    v_mfma_f32_32x32x16_bf16 v[88:103], a[4:7], a[116:119], v[88:103]
    v_mfma_f32_32x32x16_bf16 v[88:103], a[44:47], a[124:127], v[88:103]
    s_nop 8
    ds_write_b128 v3, v[72:75] offset:4096
    v_mfma_f32_32x32x16_bf16 v[88:103], v[20:23], v[108:111], v[88:103]
    ds_write_b128 v3, v[76:79] offset:5120
    v_mfma_f32_32x32x16_bf16 v[88:103], a[52:55], v[116:119], v[88:103]
    ds_write_b128 v3, v[80:83] offset:6144
    v_mfma_f32_32x32x16_bf16 v[88:103], a[12:15], v[124:127], v[88:103]
    ds_write_b128 v3, v[84:87] offset:7168
    v_mfma_f32_32x32x16_bf16 v[40:55], a[0:3], a[112:115], v[40:55]
    v_mfma_f32_32x32x16_bf16 v[40:55], a[40:43], a[120:123], v[40:55]
    s_nop 8
    ds_write_b128 v4, v[88:91] offset:0
    v_mfma_f32_32x32x16_bf16 v[40:55], v[16:19], v[104:107], v[40:55]
    ds_write_b128 v4, v[92:95] offset:1024
    v_mfma_f32_32x32x16_bf16 v[40:55], a[48:51], v[112:115], v[40:55]
    ds_write_b128 v4, v[96:99] offset:2048
    v_mfma_f32_32x32x16_bf16 v[40:55], a[8:11], v[120:123], v[40:55]
    ds_write_b128 v4, v[100:103] offset:3072
    s_lshr_b32 s12, s3, 1
    s_and_b32 s13, s3, 1
    s_lshl_b32 s14, s7, 1
    s_add_u32 s14, s14, s12
    s_lshl_b32 s14, s14, 5
    s_lshl_b32 s12, s4, 7
    s_add_u32 s12, s12, s14
    s_lshl_b32 s12, s12, 11
    s_lshl_b32 s13, s13, 7
    s_add_u32 s12, s12, s13
    s_lshl_b32 s13, s6, 8
    s_add_u32 s16, s12, s13
    s_xor_b32 s12, s3, 1
    s_mul_i32 s13, s12, 12288
    v_add_u32 v9, s13, v0
    s_lshl_b32 s12, s12, 13
    s_add_u32 s12, s12, 65536
    v_add_u32 v13, s12, v0
    s_xor_b32 s12, s3, 2
    s_mul_i32 s13, s12, 12288
    v_add_u32 v10, s13, v0
    s_lshl_b32 s12, s12, 13
    s_add_u32 s12, s12, 69632
    v_add_u32 v14, s12, v0
    s_xor_b32 s12, s3, 3
    s_mul_i32 s13, s12, 12288
    v_add_u32 v11, s13, v0
    s_lshl_b32 s12, s12, 12
    s_add_u32 s12, s12, 49152
    v_add_u32 v15, s12, v0
    v_bfe_u32 v1, v0, 4, 5
    v_lshlrev_b32 v1, 2, v1
    v_lshrrev_b32 v3, 9, v0
    v_lshl_add_u32 v1, v3, 15, v1
    s_add_u32 s16, s16, 16384
    ds_write_b128 v2, v[40:43] offset:8192
    ds_write_b128 v2, v[44:47] offset:9216
    s_waitcnt lgkmcnt(0)
    s_barrier
    ds_read_b128 v[40:43], v2 offset:0
    ds_read_b128 v[44:47], v2 offset:1024
    ds_read_b128 v[56:59], v13 offset:2048
    ds_read_b128 v[60:63], v13 offset:3072
    ds_read_b128 v[64:67], v14 offset:2048
    ds_read_b128 v[68:71], v14 offset:3072
    ds_read_b128 v[72:75], v15 offset:2048
    ds_read_b128 v[76:79], v15 offset:3072
    s_waitcnt lgkmcnt(6)
    v_pk_add_f32 v[48:49], v[48:49], v[40:41]
    v_pk_add_f32 v[50:51], v[50:51], v[42:43]
    v_pk_add_f32 v[52:53], v[52:53], v[44:45]
    v_pk_add_f32 v[54:55], v[54:55], v[46:47]
    s_waitcnt lgkmcnt(4)
    v_pk_add_f32 v[48:49], v[48:49], v[56:57]
    v_pk_add_f32 v[50:51], v[50:51], v[58:59]
    v_pk_add_f32 v[52:53], v[52:53], v[60:61]
    v_pk_add_f32 v[54:55], v[54:55], v[62:63]
    s_waitcnt lgkmcnt(2)
    v_pk_add_f32 v[48:49], v[48:49], v[64:65]
    v_pk_add_f32 v[50:51], v[50:51], v[66:67]
    v_pk_add_f32 v[52:53], v[52:53], v[68:69]
    v_pk_add_f32 v[54:55], v[54:55], v[70:71]
    s_waitcnt lgkmcnt(0)
    v_pk_add_f32 v[48:49], v[48:49], v[72:73]
    v_pk_add_f32 v[50:51], v[50:51], v[74:75]
    v_pk_add_f32 v[52:53], v[52:53], v[76:77]
    v_pk_add_f32 v[54:55], v[54:55], v[78:79]
    buffer_store_dword v48, v1, s[64:67], s16 offen offset:0 nt
    buffer_store_dword v49, v1, s[64:67], s16 offen offset:2048 nt
    s_add_u32 s16, s16, 4096
    buffer_store_dword v50, v1, s[64:67], s16 offen offset:0 nt
    buffer_store_dword v51, v1, s[64:67], s16 offen offset:2048 nt
    s_add_u32 s16, s16, 4096
    buffer_store_dword v52, v1, s[64:67], s16 offen offset:0 nt
    buffer_store_dword v53, v1, s[64:67], s16 offen offset:2048 nt
    s_add_u32 s16, s16, 4096
    buffer_store_dword v54, v1, s[64:67], s16 offen offset:0 nt
    buffer_store_dword v55, v1, s[64:67], s16 offen offset:2048 nt
    s_endpgm
PL_37:
    s_mov_b32 s24, 0
PC_39:
    s_buffer_load_dwordx8 s[92:99], s[60:63], s16 glc
    s_add_u32 s24, s24, 1
    s_cmp_gt_u32 s24, 200000
    s_cbranch_scc1 PC_39x
    s_waitcnt lgkmcnt(0)
    s_xor_b64 s[92:93], s[92:93], s[36:37]
    s_xor_b64 s[94:95], s[94:95], s[36:37]
    s_xor_b64 s[96:97], s[96:97], s[36:37]
    s_xor_b64 s[98:99], s[98:99], s[36:37]
    s_or_b64 s[92:93], s[92:93], s[94:95]
    s_or_b64 s[92:93], s[92:93], s[96:97]
    s_or_b64 s[92:93], s[92:93], s[98:99]
    s_cbranch_scc1 PC_39
PC_39x:
    s_waitcnt lgkmcnt(0)
    s_branch PD_38
PL_40:
    s_mov_b32 s24, 0
PC_42:
    s_buffer_load_dwordx8 s[92:99], s[60:63], s32 glc
    s_add_u32 s24, s24, 1
    s_cmp_gt_u32 s24, 200000
    s_cbranch_scc1 PC_42x
    s_waitcnt lgkmcnt(0)
    s_xor_b64 s[94:95], s[94:95], s[36:37]
    s_xor_b64 s[96:97], s[96:97], s[36:37]
    s_xor_b64 s[98:99], s[98:99], s[36:37]
    s_or_b64 s[94:95], s[94:95], s[96:97]
    s_or_b64 s[94:95], s[94:95], s[98:99]
    s_cbranch_scc1 PC_42
PC_42x:
    s_waitcnt lgkmcnt(0)
    s_branch PD_41
CS_43:
    s_mov_b32 s24, 0
CL_45:
    ds_read_b32 v4, v6 offset:16
    s_add_u32 s24, s24, 1
    s_waitcnt lgkmcnt(0)
    v_readfirstlane_b32 s15, v4
    s_cmp_gt_u32 s24, 200000
    s_cbranch_scc1 CB_44
    s_cmp_lt_u32 s15, 4
    s_cbranch_scc1 CL_45
    s_branch CB_44
END:
    s_endpgm
.section .rodata,"a"
.p2align 6
.amdhsa_kernel parallel_sum__ssm_conv_s5__dense_activation_relu__prompt_kernel
  .amdhsa_next_free_vgpr 256
  .amdhsa_next_free_sgpr 102
  .amdhsa_accum_offset 128
  .amdhsa_group_segment_fixed_size 0
  .amdhsa_kernarg_size 120
  .amdhsa_user_sgpr_count 2
  .amdhsa_user_sgpr_kernarg_segment_ptr 1
  .amdhsa_system_sgpr_workgroup_id_x 1
.end_amdhsa_kernel
```
